```python
import torch

def _softmax(x, axis=-1):
    return torch.softmax(x, dim=axis)
def _gelu(x):
    return torch.nn.functional.gelu(x, approximate="tanh")
def _silu(x):
    return torch.nn.functional.silu(x)
def _sigmoid(x):
    return torch.sigmoid(x)
def _layernorm(x, axis=-1, eps=1e-5):
    m = x.mean(dim=axis, keepdim=True)
    v = x.var(dim=axis, keepdim=True, unbiased=False)
    return (x - m) / torch.sqrt(v + eps)
def _scatter_add(tgt, idx, src, axis=0):
    return tgt.clone().index_add_(axis, idx, src)
def _segment_sum(src, seg, n):
    out = torch.zeros((n,) + src.shape[1:], dtype=src.dtype)
    return out.index_add_(0, seg, src)
def _pad(x, pw):
    flat = tuple(v for pair in reversed(pw) for v in pair)
    return torch.nn.functional.pad(x, flat)

kernel_name = 'standalone__fused_io_aware_attn__prompt'

def setup_inputs():

    _w = (lambda a: (lambda t: t.to(torch.bfloat16) if t.is_floating_point() else t)(torch.as_tensor(a)))
    B, H, S = 2, 32, 2048
    Dh = max(1, 512 // 32)
    return {
        "q": _w((lambda *s: torch.randn(*s, dtype=torch.bfloat16) * 0.8)(B, H, S, Dh)),
        "k": _w((lambda *s: torch.randn(*s, dtype=torch.bfloat16) * 0.8)(B, H, S, Dh)),
        "v": _w((lambda *s: torch.randn(*s, dtype=torch.bfloat16) * 0.05)(B, H, S, Dh)),
    }

def reference(q, k, v):
    scale = q.shape[-1] ** -0.5
    s = torch.einsum('bhqd,bhkd->bhqk', q, k) * scale
    p = _softmax(s, axis=-1)
    return torch.einsum('bhqk,bhkd->bhqd', p, v)
```

```asm
; @launch grid=(256,1,1) block=(512,1,1) lds=147456
.amdgcn_target "amdgcn-amd-amdhsa--gfx950"
.text
.globl standalone__fused_io_aware_attn__prompt_kernel
.p2align 8
.type standalone__fused_io_aware_attn__prompt_kernel,@function
standalone__fused_io_aware_attn__prompt_kernel:
    s_load_dwordx2 s[8:9], s[0:1], 0
    s_load_dwordx2 s[12:13], s[0:1], 8
    s_load_dwordx2 s[16:17], s[0:1], 16
    s_load_dwordx2 s[20:21], s[0:1], 24
    s_cmp_ge_u32 s2, 256
    s_cbranch_scc1 L_end
    v_lshrrev_b32 v94, 6, v0
    v_and_b32 v1, 63, v0
    v_readfirstlane_b32 s24, v94
    s_and_b32 s25, s2, 7
    s_lshl_b32 s25, s25, 19
    s_lshr_b32 s27, s2, 3
    s_lshl_b32 s27, s27, 14
    s_add_u32 s27, s27, s25
    s_and_b32 s25, s27, 0xffff0000
    v_and_b32 v7, 31, v1
    v_lshlrev_b32 v7, 5, v7
    v_lshrrev_b32 v2, 5, v1
    v_lshl_add_u32 v7, v2, 4, v7
    v_lshl_add_u32 v6, v94, 11, v7
    v_add_u32 v6, s27, v6
    v_lshlrev_b32 v2, 4, v1
    s_lshl_b32 s29, s24, 10
    s_add_u32 s28, s29, s25
    s_add_u32 s26, s25, 4096
    s_mov_b32 s10, 0x400000
    s_mov_b32 s11, 0x00020000
    s_mov_b32 s14, 0x400000
    s_mov_b32 s15, 0x00020000
    s_mov_b32 s18, 0x400000
    s_mov_b32 s19, 0x00020000
    s_mov_b32 s22, 0x400000
    s_mov_b32 s23, 0x00020000
    s_mov_b32 m0, s29
    s_add_u32 s27, s29, 65536
    s_cmp_ge_u32 s24, 4
    s_waitcnt lgkmcnt(0)
    s_cbranch_scc1 L_late0
    buffer_load_dwordx4 v[8:11], v6, s[8:11], 0 offen offset:0
    buffer_load_dwordx4 v[16:19], v7, s[12:15], s25 offen offset:0
    buffer_load_dwordx4 v[20:23], v7, s[12:15], s25 offen offset:1024
    buffer_load_dwordx4 v[24:27], v7, s[12:15], s25 offen offset:2048
    buffer_load_dwordx4 v[28:31], v7, s[12:15], s25 offen offset:3072
L_late0:
    buffer_load_dwordx4 v7, s[12:15], s28 offen lds
    s_mov_b32 m0, s27
    s_mov_b32 s30, 0x3eb8aa3b
    buffer_load_dwordx4 v2, s[16:19], s28 offen lds
    s_mov_b32 s31, 0x3eb8aa3b
    s_cbranch_scc1 L_late1
    buffer_load_dwordx4 v[32:35], v7, s[12:15], s26 offen offset:0
    buffer_load_dwordx4 v[36:39], v7, s[12:15], s26 offen offset:1024
L_late1:
    v_mov_b32 v88, 0x3f80
    v_mov_b32 v89, 0
    v_lshrrev_b32 v90, 1, v1
    v_lshlrev_b32 v90, 9, v90
    v_and_b32 v91, 1, v1
    v_lshl_add_u32 v90, v91, 7, v90
    v_add_u32 v92, 131200, v90
    v_mov_b32 v90, 0
    v_mov_b32 v91, 0
    ds_write_b128 v92, v[88:91]
    v_and_b32 v94, 15, v1
    v_lshlrev_b32 v94, 3, v94
    v_lshrrev_b32 v0, 5, v1
    v_lshl_add_u32 v3, v0, 8, v94
    v_add_u32 v3, 65536, v3
    v_and_b32 v94, 2, v1
    v_lshlrev_b32 v94, 2, v94
    v_add_u32 v94, 131200, v94
    v_and_b32 v0, 16, v1
    v_cmp_eq_u32 vcc, 0, v0
    v_mov_b32 v4, 8192
    v_mov_b32 v5, 0xdddddddd
    v_cndmask_b32 v3, v94, v3, vcc
    v_cndmask_b32 v4, 0, v4, vcc
    v_pk_mov_b32 v[96:97], 0, 0
    v_pk_mov_b32 v[98:99], 0, 0
    v_pk_mov_b32 v[100:101], 0, 0
    v_pk_mov_b32 v[102:103], 0, 0
    v_pk_mov_b32 v[104:105], 0, 0
    v_pk_mov_b32 v[106:107], 0, 0
    v_pk_mov_b32 v[108:109], 0, 0
    v_pk_mov_b32 v[110:111], 0, 0
    v_pk_mov_b32 v[112:113], 0, 0
    v_pk_mov_b32 v[114:115], 0, 0
    v_pk_mov_b32 v[116:117], 0, 0
    v_pk_mov_b32 v[118:119], 0, 0
    v_pk_mov_b32 v[120:121], 0, 0
    v_pk_mov_b32 v[122:123], 0, 0
    v_pk_mov_b32 v[124:125], 0, 0
    v_pk_mov_b32 v[126:127], 0, 0
    s_cmp_lt_u32 s24, 4
    s_cbranch_scc1 L_early1
    buffer_load_dwordx4 v[8:11], v6, s[8:11], 0 offen offset:0
    s_waitcnt vmcnt(1) lgkmcnt(0)
    s_barrier
    buffer_load_dwordx4 v[12:15], v6, s[8:11], 0 offen offset:1024
    ds_read_b128 v[16:19], v2 offset:0
    ds_read_b128 v[20:23], v2 offset:1024
    ds_read_b128 v[24:27], v2 offset:2048
    ds_read_b128 v[28:31], v2 offset:3072
    ds_read_b128 v[32:35], v2 offset:4096
    ds_read_b128 v[36:39], v2 offset:5120
    s_waitcnt vmcnt(1)
    s_branch L_go
L_early1:
    s_waitcnt vmcnt(8)
    buffer_load_dwordx4 v[12:15], v6, s[8:11], 0 offen offset:1024
L_go:
    v_lshlrev_b32 v88, 16, v8
    v_and_b32 v89, 0xffff0000, v8
    v_lshlrev_b32 v90, 16, v9
    v_and_b32 v91, 0xffff0000, v9
    v_pk_mul_f32 v[88:89], v[88:89], s[30:31]
    v_pk_mul_f32 v[90:91], v[90:91], s[30:31]
    v_cvt_pk_bf16_f32 v8, v88, v89
    v_cvt_pk_bf16_f32 v9, v90, v91
    v_lshlrev_b32 v88, 16, v10
    v_and_b32 v89, 0xffff0000, v10
    v_lshlrev_b32 v90, 16, v11
    v_and_b32 v91, 0xffff0000, v11
    v_pk_mul_f32 v[88:89], v[88:89], s[30:31]
    v_pk_mul_f32 v[90:91], v[90:91], s[30:31]
    v_cvt_pk_bf16_f32 v10, v88, v89
    v_cvt_pk_bf16_f32 v11, v90, v91
    s_waitcnt vmcnt(8) lgkmcnt(0)
    s_nop 0
    v_mfma_f32_32x32x16_bf16 v[128:143], v[16:19], v[8:11], 4.0
    s_nop 10
    s_setprio 3
    v_exp_f32 v128, v128
    v_exp_f32 v129, v129
    v_exp_f32 v130, v130
    v_exp_f32 v131, v131
    s_waitcnt vmcnt(7)
    v_mfma_f32_32x32x16_bf16 v[144:159], v[20:23], v[8:11], 4.0
    v_exp_f32 v132, v132
    v_exp_f32 v133, v133
    v_exp_f32 v134, v134
    v_exp_f32 v135, v135
    v_exp_f32 v136, v136
    v_exp_f32 v137, v137
    v_exp_f32 v138, v138
    v_exp_f32 v139, v139
    v_exp_f32 v140, v140
    v_exp_f32 v141, v141
    v_exp_f32 v142, v142
    v_exp_f32 v143, v143
    v_exp_f32 v144, v144
    v_exp_f32 v145, v145
    v_exp_f32 v146, v146
    v_exp_f32 v147, v147
    s_waitcnt vmcnt(6)
    v_mfma_f32_32x32x16_bf16 v[160:175], v[24:27], v[8:11], 4.0
    v_exp_f32 v148, v148
    v_exp_f32 v149, v149
    v_exp_f32 v150, v150
    v_exp_f32 v151, v151
    v_exp_f32 v152, v152
    v_exp_f32 v153, v153
    v_exp_f32 v154, v154
    v_exp_f32 v155, v155
    v_exp_f32 v156, v156
    v_exp_f32 v157, v157
    v_exp_f32 v158, v158
    v_exp_f32 v159, v159
    v_exp_f32 v160, v160
    v_exp_f32 v161, v161
    v_exp_f32 v162, v162
    v_exp_f32 v163, v163
    s_waitcnt vmcnt(5)
    v_mfma_f32_32x32x16_bf16 v[176:191], v[28:31], v[8:11], 4.0
    v_exp_f32 v164, v164
    v_exp_f32 v165, v165
    v_exp_f32 v166, v166
    v_exp_f32 v167, v167
    v_exp_f32 v168, v168
    v_exp_f32 v169, v169
    v_exp_f32 v170, v170
    v_exp_f32 v171, v171
    v_exp_f32 v172, v172
    v_exp_f32 v173, v173
    v_exp_f32 v174, v174
    v_exp_f32 v175, v175
    v_exp_f32 v176, v176
    v_exp_f32 v177, v177
    v_exp_f32 v178, v178
    v_exp_f32 v179, v179
    s_waitcnt vmcnt(2)
    v_mfma_f32_32x32x16_bf16 v[192:207], v[32:35], v[8:11], 4.0
    v_exp_f32 v180, v180
    v_exp_f32 v181, v181
    v_exp_f32 v182, v182
    v_exp_f32 v183, v183
    v_exp_f32 v184, v184
    v_exp_f32 v185, v185
    v_exp_f32 v186, v186
    v_exp_f32 v187, v187
    v_exp_f32 v188, v188
    v_exp_f32 v189, v189
    v_exp_f32 v190, v190
    v_exp_f32 v191, v191
    v_exp_f32 v192, v192
    v_exp_f32 v193, v193
    v_exp_f32 v194, v194
    v_exp_f32 v195, v195
    s_waitcnt vmcnt(1)
    v_mfma_f32_32x32x16_bf16 v[208:223], v[36:39], v[8:11], 4.0
    v_exp_f32 v196, v196
    v_exp_f32 v197, v197
    v_exp_f32 v198, v198
    v_exp_f32 v199, v199
    v_exp_f32 v200, v200
    v_exp_f32 v201, v201
    v_exp_f32 v202, v202
    v_exp_f32 v203, v203
    v_exp_f32 v204, v204
    v_exp_f32 v205, v205
    v_exp_f32 v206, v206
    v_exp_f32 v207, v207
    s_cmp_ge_u32 s24, 4
    s_cbranch_scc1 L_late2
    s_waitcnt vmcnt(1) lgkmcnt(0)
    s_barrier
L_late2:
    s_add_u32 s28, s28, 8192
    s_add_u32 m0, s29, 8192
    ds_read_b64_tr_b16 v[40:41], v3 offset:0
    ds_read_b64_tr_b16 v[42:43], v3 offset:128
    ds_read_b64_tr_b16 v[44:45], v3 offset:512
    buffer_load_dwordx4 v7, s[12:15], s28 offen lds
    s_add_u32 m0, s29, 73728
    ds_read_b64_tr_b16 v[46:47], v3 offset:640
    ds_read_b128 v[16:19], v2 offset:6144
    buffer_load_dwordx4 v2, s[16:19], s28 offen lds
    v_exp_f32 v208, v208
    ds_read_b64_tr_b16 v[48:49], v3 offset:1024
    v_exp_f32 v209, v209
    ds_read_b64_tr_b16 v[50:51], v3 offset:1152
    v_exp_f32 v210, v210
    ds_read_b64_tr_b16 v[52:53], v3 offset:1536
    v_exp_f32 v211, v211
    ds_read_b64_tr_b16 v[54:55], v3 offset:1664
    v_exp_f32 v212, v212
    ds_read_b128 v[20:23], v2 offset:7168
    v_exp_f32 v213, v213
    s_waitcnt lgkmcnt(8)
    v_smfmac_f32_32x32x32_bf16 v[96:111], v[40:43], v[128:135], v5
    ds_read_b64_tr_b16 v[56:57], v3 offset:2048
    v_exp_f32 v214, v214
    s_waitcnt lgkmcnt(7)
    v_smfmac_f32_32x32x32_bf16 v[96:111], v[44:47], v[136:143], v5
    ds_read_b64_tr_b16 v[58:59], v3 offset:2176
    v_exp_f32 v215, v215
    ds_read_b64_tr_b16 v[60:61], v3 offset:2560
    v_exp_f32 v216, v216
    s_waitcnt lgkmcnt(8)
    v_mfma_f32_32x32x16_bf16 v[128:143], v[16:19], v[8:11], 4.0
    ds_read_b64_tr_b16 v[62:63], v3 offset:2688
    v_exp_f32 v217, v217
    ds_read_b64_tr_b16 v[64:65], v3 offset:3072
    v_exp_f32 v218, v218
    s_waitcnt lgkmcnt(8)
    v_smfmac_f32_32x32x32_bf16 v[96:111], v[48:51], v[144:151], v5
    ds_read_b64_tr_b16 v[66:67], v3 offset:3200
    v_exp_f32 v219, v219
    ds_read_b64_tr_b16 v[68:69], v3 offset:3584
    v_exp_f32 v220, v220
    s_waitcnt lgkmcnt(8)
    v_smfmac_f32_32x32x32_bf16 v[96:111], v[52:55], v[152:159], v5
    ds_read_b64_tr_b16 v[70:71], v3 offset:3712
    v_exp_f32 v221, v221
    v_exp_f32 v222, v222
    v_exp_f32 v223, v223
    v_exp_f32 v128, v128
    ds_read_b64_tr_b16 v[40:41], v3 offset:6144
    v_exp_f32 v129, v129
    s_waitcnt lgkmcnt(7)
    v_smfmac_f32_32x32x32_bf16 v[96:111], v[56:59], v[160:167], v5
    ds_read_b64_tr_b16 v[42:43], v3 offset:6272
    v_exp_f32 v130, v130
    ds_read_b64_tr_b16 v[44:45], v3 offset:6656
    v_exp_f32 v131, v131
    v_mfma_f32_32x32x16_bf16 v[144:159], v[20:23], v[8:11], 4.0
    ds_read_b64_tr_b16 v[46:47], v3 offset:6784
    v_exp_f32 v132, v132
    ds_read_b64_tr_b16 v[72:73], v3 offset:4096
    v_exp_f32 v133, v133
    s_waitcnt lgkmcnt(9)
    v_smfmac_f32_32x32x32_bf16 v[96:111], v[60:63], v[168:175], v5
    ds_read_b64_tr_b16 v[74:75], v3 offset:4224
    v_exp_f32 v134, v134
    ds_read_b64_tr_b16 v[76:77], v3 offset:4608
    v_exp_f32 v135, v135
    s_waitcnt lgkmcnt(9)
    v_smfmac_f32_32x32x32_bf16 v[96:111], v[64:67], v[176:183], v5
    ds_read_b64_tr_b16 v[78:79], v3 offset:4736
    v_exp_f32 v136, v136
    ds_read_b64_tr_b16 v[80:81], v3 offset:5120
    v_exp_f32 v137, v137
    ds_read_b64_tr_b16 v[82:83], v3 offset:5248
    v_exp_f32 v138, v138
    s_waitcnt lgkmcnt(8)
    v_smfmac_f32_32x32x32_bf16 v[96:111], v[40:43], v[128:135], v5
    ds_read_b64_tr_b16 v[48:49], v3 offset:7168
    v_exp_f32 v139, v139
    ds_read_b64_tr_b16 v[50:51], v3 offset:7296
    v_exp_f32 v140, v140
    v_smfmac_f32_32x32x32_bf16 v[96:111], v[68:71], v[184:191], v5
    v_exp_f32 v141, v141
    v_exp_f32 v142, v142
    v_exp_f32 v143, v143
    s_waitcnt vmcnt(2)
    v_lshlrev_b32 v88, 16, v12
    v_and_b32 v89, 0xffff0000, v12
    v_lshlrev_b32 v90, 16, v13
    v_and_b32 v91, 0xffff0000, v13
    v_pk_mul_f32 v[88:89], v[88:89], s[30:31]
    v_pk_mul_f32 v[90:91], v[90:91], s[30:31]
    v_cvt_pk_bf16_f32 v12, v88, v89
    v_cvt_pk_bf16_f32 v13, v90, v91
    v_lshlrev_b32 v88, 16, v14
    v_and_b32 v89, 0xffff0000, v14
    v_lshlrev_b32 v90, 16, v15
    v_and_b32 v91, 0xffff0000, v15
    v_pk_mul_f32 v[88:89], v[88:89], s[30:31]
    v_pk_mul_f32 v[90:91], v[90:91], s[30:31]
    v_cvt_pk_bf16_f32 v14, v88, v89
    v_cvt_pk_bf16_f32 v15, v90, v91
    v_exp_f32 v144, v144
    ds_read_b64_tr_b16 v[84:85], v3 offset:5632
    v_exp_f32 v145, v145
    s_waitcnt lgkmcnt(9)
    v_smfmac_f32_32x32x32_bf16 v[96:111], v[44:47], v[136:143], v5
    ds_read_b64_tr_b16 v[86:87], v3 offset:5760
    v_exp_f32 v146, v146
    ds_read_b64_tr_b16 v[52:53], v3 offset:7680
    v_exp_f32 v147, v147
    s_waitcnt lgkmcnt(9)
    v_smfmac_f32_32x32x32_bf16 v[96:111], v[72:75], v[192:199], v5
    ds_read_b64_tr_b16 v[54:55], v3 offset:7808
    v_exp_f32 v148, v148
    v_mfma_f32_32x32x16_bf16 v[128:143], v[24:27], v[12:15], 4.0
    v_exp_f32 v149, v149
    v_exp_f32 v150, v150
    s_waitcnt lgkmcnt(8)
    v_smfmac_f32_32x32x32_bf16 v[96:111], v[76:79], v[200:207], v5
    v_exp_f32 v151, v151
    v_exp_f32 v152, v152
    s_waitcnt lgkmcnt(6)
    v_smfmac_f32_32x32x32_bf16 v[96:111], v[80:83], v[208:215], v5
    v_exp_f32 v153, v153
    v_exp_f32 v154, v154
    s_waitcnt lgkmcnt(4)
    v_smfmac_f32_32x32x32_bf16 v[96:111], v[48:51], v[144:151], v5
    v_exp_f32 v155, v155
    v_exp_f32 v156, v156
    s_waitcnt lgkmcnt(2)
    v_smfmac_f32_32x32x32_bf16 v[96:111], v[84:87], v[216:223], v5
    v_exp_f32 v157, v157
    v_exp_f32 v158, v158
    v_exp_f32 v159, v159
    s_waitcnt lgkmcnt(0)
    s_setprio 2
    v_exp_f32 v128, v128
    v_exp_f32 v129, v129
    v_smfmac_f32_32x32x32_bf16 v[96:111], v[52:55], v[152:159], v5
    v_exp_f32 v130, v130
    v_exp_f32 v131, v131
    v_exp_f32 v132, v132
    v_mfma_f32_32x32x16_bf16 v[144:159], v[28:31], v[12:15], 4.0
    v_exp_f32 v133, v133
    v_exp_f32 v134, v134
    v_exp_f32 v135, v135
    v_exp_f32 v136, v136
    v_exp_f32 v137, v137
    v_exp_f32 v138, v138
    v_smfmac_f32_32x32x32_bf16 v[112:127], v[56:59], v[128:135], v5
    v_exp_f32 v139, v139
    v_exp_f32 v140, v140
    s_add_u32 s28, s28, 8192
    s_add_u32 m0, s29, 16384
    v_exp_f32 v141, v141
    buffer_load_dwordx4 v7, s[12:15], s28 offen lds
    v_exp_f32 v142, v142
    v_exp_f32 v143, v143
    v_exp_f32 v144, v144
    v_exp_f32 v145, v145
    v_smfmac_f32_32x32x32_bf16 v[112:127], v[60:63], v[136:143], v5
    v_exp_f32 v146, v146
    v_exp_f32 v147, v147
    v_exp_f32 v148, v148
    v_mfma_f32_32x32x16_bf16 v[128:143], v[32:35], v[12:15], 4.0
    v_exp_f32 v149, v149
    v_exp_f32 v150, v150
    v_exp_f32 v151, v151
    v_exp_f32 v152, v152
    v_exp_f32 v153, v153
    v_exp_f32 v154, v154
    v_smfmac_f32_32x32x32_bf16 v[112:127], v[64:67], v[144:151], v5
    v_exp_f32 v155, v155
    v_exp_f32 v156, v156
    v_exp_f32 v157, v157
    v_exp_f32 v158, v158
    v_exp_f32 v159, v159
    v_exp_f32 v128, v128
    v_exp_f32 v129, v129
    v_smfmac_f32_32x32x32_bf16 v[112:127], v[68:71], v[152:159], v5
    v_exp_f32 v130, v130
    v_exp_f32 v131, v131
    v_exp_f32 v132, v132
    v_mfma_f32_32x32x16_bf16 v[144:159], v[36:39], v[12:15], 4.0
    v_exp_f32 v133, v133
    v_exp_f32 v134, v134
    v_exp_f32 v135, v135
    v_exp_f32 v136, v136
    v_exp_f32 v137, v137
    v_exp_f32 v138, v138
    v_smfmac_f32_32x32x32_bf16 v[112:127], v[72:75], v[128:135], v5
    v_exp_f32 v139, v139
    v_exp_f32 v140, v140
    v_exp_f32 v141, v141
    v_exp_f32 v142, v142
    v_exp_f32 v143, v143
    v_exp_f32 v144, v144
    v_exp_f32 v145, v145
    v_smfmac_f32_32x32x32_bf16 v[112:127], v[76:79], v[136:143], v5
    v_exp_f32 v146, v146
    v_exp_f32 v147, v147
    v_exp_f32 v148, v148
    v_mfma_f32_32x32x16_bf16 v[128:143], v[16:19], v[12:15], 4.0
    v_exp_f32 v149, v149
    v_exp_f32 v150, v150
    v_exp_f32 v151, v151
    v_exp_f32 v152, v152
    v_exp_f32 v153, v153
    v_exp_f32 v154, v154
    v_smfmac_f32_32x32x32_bf16 v[112:127], v[80:83], v[144:151], v5
    v_exp_f32 v155, v155
    v_exp_f32 v156, v156
    s_add_u32 m0, s29, 81920
    v_exp_f32 v157, v157
    buffer_load_dwordx4 v2, s[16:19], s28 offen lds
    v_exp_f32 v158, v158
    v_exp_f32 v159, v159
    s_setprio 1
    v_exp_f32 v128, v128
    v_exp_f32 v129, v129
    v_smfmac_f32_32x32x32_bf16 v[112:127], v[84:87], v[152:159], v5
    ds_read_b128 v[24:27], v2 offset:0
    v_exp_f32 v130, v130
    v_exp_f32 v131, v131
    v_exp_f32 v132, v132
    v_mfma_f32_32x32x16_bf16 v[144:159], v[20:23], v[12:15], 4.0
    v_exp_f32 v133, v133
    v_exp_f32 v134, v134
    v_exp_f32 v135, v135
    v_exp_f32 v136, v136
    v_exp_f32 v137, v137
    v_exp_f32 v138, v138
    v_smfmac_f32_32x32x32_bf16 v[112:127], v[40:43], v[128:135], v5
    v_exp_f32 v139, v139
    v_exp_f32 v140, v140
    v_exp_f32 v141, v141
    v_exp_f32 v142, v142
    v_exp_f32 v143, v143
    s_waitcnt lgkmcnt(0)
    s_setprio 0
    v_exp_f32 v144, v144
    v_exp_f32 v145, v145
    v_smfmac_f32_32x32x32_bf16 v[112:127], v[44:47], v[136:143], v5
    ds_read_b128 v[28:31], v2 offset:1024
    ds_read_b64_tr_b16 v[56:57], v3 offset:0
    v_exp_f32 v146, v146
    v_exp_f32 v147, v147
    v_exp_f32 v148, v148
    v_mfma_f32_32x32x16_bf16 v[128:143], v[24:27], v[12:15], 4.0
    ds_read_b64_tr_b16 v[58:59], v3 offset:128
    ds_read_b64_tr_b16 v[60:61], v3 offset:512
    v_exp_f32 v149, v149
    v_exp_f32 v150, v150
    v_exp_f32 v151, v151
    v_exp_f32 v152, v152
    v_exp_f32 v153, v153
    v_exp_f32 v154, v154
    v_smfmac_f32_32x32x32_bf16 v[112:127], v[48:51], v[144:151], v5
    ds_read_b64_tr_b16 v[62:63], v3 offset:640
    v_exp_f32 v155, v155
    v_exp_f32 v156, v156
    v_exp_f32 v157, v157
    v_exp_f32 v158, v158
    v_exp_f32 v159, v159
    s_waitcnt vmcnt(2) lgkmcnt(2)
    s_barrier
    s_setprio 3
    v_exp_f32 v128, v128
    v_exp_f32 v129, v129
    v_smfmac_f32_32x32x32_bf16 v[112:127], v[52:55], v[152:159], v5
    ds_read_b128 v[16:19], v2 offset:8192
    ds_read_b64_tr_b16 v[64:65], v3 offset:1024
    v_exp_f32 v130, v130
    v_exp_f32 v131, v131
    v_exp_f32 v132, v132
    v_mfma_f32_32x32x16_bf16 v[144:159], v[28:31], v[12:15], 4.0
    ds_read_b64_tr_b16 v[66:67], v3 offset:1152
    ds_read_b64_tr_b16 v[68:69], v3 offset:1536
    v_exp_f32 v133, v133
    v_exp_f32 v134, v134
    v_exp_f32 v135, v135
    v_exp_f32 v136, v136
    v_exp_f32 v137, v137
    v_exp_f32 v138, v138
    v_smfmac_f32_32x32x32_bf16 v[112:127], v[56:59], v[128:135], v5
    ds_read_b64_tr_b16 v[70:71], v3 offset:1664
    v_exp_f32 v139, v139
    v_exp_f32 v140, v140
    s_add_u32 s28, s28, 8192
    s_add_u32 m0, s29, 24576
    v_exp_f32 v141, v141
    buffer_load_dwordx4 v7, s[12:15], s28 offen lds
    v_exp_f32 v142, v142
    v_exp_f32 v143, v143
    s_waitcnt lgkmcnt(2)
    v_add_u32 v3, v4, v3
    v_exp_f32 v144, v144
    v_exp_f32 v145, v145
    v_smfmac_f32_32x32x32_bf16 v[112:127], v[60:63], v[136:143], v5
    ds_read_b128 v[20:23], v2 offset:9216
    ds_read_b64_tr_b16 v[40:41], v3 offset:0
    v_exp_f32 v146, v146
    v_exp_f32 v147, v147
    v_exp_f32 v148, v148
    v_mfma_f32_32x32x16_bf16 v[128:143], v[16:19], v[8:11], 4.0
    ds_read_b64_tr_b16 v[42:43], v3 offset:128
    ds_read_b64_tr_b16 v[44:45], v3 offset:512
    v_exp_f32 v149, v149
    v_exp_f32 v150, v150
    v_exp_f32 v151, v151
    v_exp_f32 v152, v152
    v_exp_f32 v153, v153
    v_exp_f32 v154, v154
    v_smfmac_f32_32x32x32_bf16 v[112:127], v[64:67], v[144:151], v5
    ds_read_b64_tr_b16 v[46:47], v3 offset:640
    v_exp_f32 v155, v155
    v_exp_f32 v156, v156
    v_exp_f32 v157, v157
    v_exp_f32 v158, v158
    v_exp_f32 v159, v159
    s_waitcnt lgkmcnt(2)
    v_exp_f32 v128, v128
    v_exp_f32 v129, v129
    v_smfmac_f32_32x32x32_bf16 v[112:127], v[68:71], v[152:159], v5
    ds_read_b64_tr_b16 v[48:49], v3 offset:1024
    v_exp_f32 v130, v130
    v_exp_f32 v131, v131
    v_exp_f32 v132, v132
    v_mfma_f32_32x32x16_bf16 v[144:159], v[16:19], v[12:15], 4.0
    ds_read_b64_tr_b16 v[50:51], v3 offset:1152
    v_exp_f32 v133, v133
    v_exp_f32 v134, v134
    v_exp_f32 v135, v135
    v_exp_f32 v136, v136
    v_exp_f32 v137, v137
    v_exp_f32 v138, v138
    v_smfmac_f32_32x32x32_bf16 v[96:111], v[40:43], v[128:135], v5
    v_exp_f32 v139, v139
    v_exp_f32 v140, v140
    v_exp_f32 v141, v141
    v_exp_f32 v142, v142
    v_exp_f32 v143, v143
    s_waitcnt lgkmcnt(0)
    v_exp_f32 v144, v144
    v_exp_f32 v145, v145
    v_smfmac_f32_32x32x32_bf16 v[96:111], v[44:47], v[136:143], v5
    ds_read_b64_tr_b16 v[52:53], v3 offset:1536
    v_exp_f32 v146, v146
    v_exp_f32 v147, v147
    v_exp_f32 v148, v148
    v_mfma_f32_32x32x16_bf16 v[128:143], v[20:23], v[8:11], 4.0
    ds_read_b64_tr_b16 v[54:55], v3 offset:1664
    v_exp_f32 v149, v149
    v_exp_f32 v150, v150
    v_exp_f32 v151, v151
    v_exp_f32 v152, v152
    v_exp_f32 v153, v153
    v_exp_f32 v154, v154
    v_smfmac_f32_32x32x32_bf16 v[112:127], v[40:43], v[144:151], v5
    ds_read_b128 v[16:19], v2 offset:10240
    v_exp_f32 v155, v155
    v_exp_f32 v156, v156
    s_add_u32 m0, s29, 90112
    v_exp_f32 v157, v157
    buffer_load_dwordx4 v2, s[16:19], s28 offen lds
    v_exp_f32 v158, v158
    v_exp_f32 v159, v159
    s_setprio 2
    v_exp_f32 v128, v128
    v_exp_f32 v129, v129
    v_smfmac_f32_32x32x32_bf16 v[112:127], v[44:47], v[152:159], v5
    ds_read_b64_tr_b16 v[40:41], v3 offset:2048
    v_exp_f32 v130, v130
    v_exp_f32 v131, v131
    v_exp_f32 v132, v132
    v_mfma_f32_32x32x16_bf16 v[144:159], v[20:23], v[12:15], 4.0
    ds_read_b64_tr_b16 v[42:43], v3 offset:2176
    v_exp_f32 v133, v133
    v_exp_f32 v134, v134
    v_exp_f32 v135, v135
    v_exp_f32 v136, v136
    v_exp_f32 v137, v137
    v_exp_f32 v138, v138
    v_smfmac_f32_32x32x32_bf16 v[96:111], v[48:51], v[128:135], v5
    v_exp_f32 v139, v139
    v_exp_f32 v140, v140
    v_exp_f32 v141, v141
    v_exp_f32 v142, v142
    v_exp_f32 v143, v143
    s_waitcnt lgkmcnt(0)
    v_exp_f32 v144, v144
    v_exp_f32 v145, v145
    v_smfmac_f32_32x32x32_bf16 v[96:111], v[52:55], v[136:143], v5
    ds_read_b64_tr_b16 v[44:45], v3 offset:2560
    v_exp_f32 v146, v146
    v_exp_f32 v147, v147
    v_exp_f32 v148, v148
    v_mfma_f32_32x32x16_bf16 v[128:143], v[16:19], v[8:11], 4.0
    ds_read_b64_tr_b16 v[46:47], v3 offset:2688
    v_exp_f32 v149, v149
    v_exp_f32 v150, v150
    v_exp_f32 v151, v151
    v_exp_f32 v152, v152
    v_exp_f32 v153, v153
    v_exp_f32 v154, v154
    v_smfmac_f32_32x32x32_bf16 v[112:127], v[48:51], v[144:151], v5
    ds_read_b128 v[20:23], v2 offset:11264
    v_exp_f32 v155, v155
    v_exp_f32 v156, v156
    v_exp_f32 v157, v157
    v_exp_f32 v158, v158
    v_exp_f32 v159, v159
    v_exp_f32 v128, v128
    v_exp_f32 v129, v129
    v_smfmac_f32_32x32x32_bf16 v[112:127], v[52:55], v[152:159], v5
    ds_read_b64_tr_b16 v[48:49], v3 offset:3072
    v_exp_f32 v130, v130
    v_exp_f32 v131, v131
    v_exp_f32 v132, v132
    v_mfma_f32_32x32x16_bf16 v[144:159], v[16:19], v[12:15], 4.0
    ds_read_b64_tr_b16 v[50:51], v3 offset:3200
    v_exp_f32 v133, v133
    v_exp_f32 v134, v134
    v_exp_f32 v135, v135
    v_exp_f32 v136, v136
    v_exp_f32 v137, v137
    v_exp_f32 v138, v138
    v_smfmac_f32_32x32x32_bf16 v[96:111], v[40:43], v[128:135], v5
    v_exp_f32 v139, v139
    v_exp_f32 v140, v140
    s_add_u32 s28, s28, 8192
    s_add_u32 m0, s29, 32768
    v_exp_f32 v141, v141
    buffer_load_dwordx4 v7, s[12:15], s28 offen lds
    v_exp_f32 v142, v142
    v_exp_f32 v143, v143
    s_waitcnt lgkmcnt(0)
    v_exp_f32 v144, v144
    v_exp_f32 v145, v145
    v_smfmac_f32_32x32x32_bf16 v[96:111], v[44:47], v[136:143], v5
    ds_read_b64_tr_b16 v[52:53], v3 offset:3584
    v_exp_f32 v146, v146
    v_exp_f32 v147, v147
    v_exp_f32 v148, v148
    v_mfma_f32_32x32x16_bf16 v[128:143], v[20:23], v[8:11], 4.0
    ds_read_b64_tr_b16 v[54:55], v3 offset:3712
    v_exp_f32 v149, v149
    v_exp_f32 v150, v150
    v_exp_f32 v151, v151
    v_exp_f32 v152, v152
    v_exp_f32 v153, v153
    v_exp_f32 v154, v154
    v_smfmac_f32_32x32x32_bf16 v[112:127], v[40:43], v[144:151], v5
    ds_read_b128 v[16:19], v2 offset:12288
    v_exp_f32 v155, v155
    v_exp_f32 v156, v156
    v_exp_f32 v157, v157
    v_exp_f32 v158, v158
    v_exp_f32 v159, v159
    v_exp_f32 v128, v128
    v_exp_f32 v129, v129
    v_smfmac_f32_32x32x32_bf16 v[112:127], v[44:47], v[152:159], v5
    ds_read_b64_tr_b16 v[40:41], v3 offset:4096
    v_exp_f32 v130, v130
    v_exp_f32 v131, v131
    v_exp_f32 v132, v132
    v_mfma_f32_32x32x16_bf16 v[144:159], v[20:23], v[12:15], 4.0
    ds_read_b64_tr_b16 v[42:43], v3 offset:4224
    v_exp_f32 v133, v133
    v_exp_f32 v134, v134
    v_exp_f32 v135, v135
    v_exp_f32 v136, v136
    v_exp_f32 v137, v137
    v_exp_f32 v138, v138
    v_smfmac_f32_32x32x32_bf16 v[96:111], v[48:51], v[128:135], v5
    v_exp_f32 v139, v139
    v_exp_f32 v140, v140
    v_exp_f32 v141, v141
    v_exp_f32 v142, v142
    v_exp_f32 v143, v143
    s_waitcnt lgkmcnt(0)
    v_exp_f32 v144, v144
    v_exp_f32 v145, v145
    v_smfmac_f32_32x32x32_bf16 v[96:111], v[52:55], v[136:143], v5
    ds_read_b64_tr_b16 v[44:45], v3 offset:4608
    v_exp_f32 v146, v146
    v_exp_f32 v147, v147
    v_exp_f32 v148, v148
    v_mfma_f32_32x32x16_bf16 v[128:143], v[16:19], v[8:11], 4.0
    ds_read_b64_tr_b16 v[46:47], v3 offset:4736
    v_exp_f32 v149, v149
    v_exp_f32 v150, v150
    v_exp_f32 v151, v151
    v_exp_f32 v152, v152
    v_exp_f32 v153, v153
    v_exp_f32 v154, v154
    v_smfmac_f32_32x32x32_bf16 v[112:127], v[48:51], v[144:151], v5
    ds_read_b128 v[20:23], v2 offset:13312
    v_exp_f32 v155, v155
    v_exp_f32 v156, v156
    s_add_u32 m0, s29, 98304
    v_exp_f32 v157, v157
    buffer_load_dwordx4 v2, s[16:19], s28 offen lds
    v_exp_f32 v158, v158
    v_exp_f32 v159, v159
    v_exp_f32 v128, v128
    v_exp_f32 v129, v129
    v_smfmac_f32_32x32x32_bf16 v[112:127], v[52:55], v[152:159], v5
    ds_read_b64_tr_b16 v[48:49], v3 offset:5120
    v_exp_f32 v130, v130
    v_exp_f32 v131, v131
    v_exp_f32 v132, v132
    v_mfma_f32_32x32x16_bf16 v[144:159], v[16:19], v[12:15], 4.0
    ds_read_b64_tr_b16 v[50:51], v3 offset:5248
    v_exp_f32 v133, v133
    v_exp_f32 v134, v134
    v_exp_f32 v135, v135
    v_exp_f32 v136, v136
    v_exp_f32 v137, v137
    v_exp_f32 v138, v138
    v_smfmac_f32_32x32x32_bf16 v[96:111], v[40:43], v[128:135], v5
    v_exp_f32 v139, v139
    v_exp_f32 v140, v140
    v_exp_f32 v141, v141
    v_exp_f32 v142, v142
    v_exp_f32 v143, v143
    s_waitcnt lgkmcnt(0)
    v_exp_f32 v144, v144
    v_exp_f32 v145, v145
    v_smfmac_f32_32x32x32_bf16 v[96:111], v[44:47], v[136:143], v5
    ds_read_b64_tr_b16 v[52:53], v3 offset:5632
    v_exp_f32 v146, v146
    v_exp_f32 v147, v147
    v_exp_f32 v148, v148
    v_mfma_f32_32x32x16_bf16 v[128:143], v[20:23], v[8:11], 4.0
    ds_read_b64_tr_b16 v[54:55], v3 offset:5760
    v_exp_f32 v149, v149
    v_exp_f32 v150, v150
    v_exp_f32 v151, v151
    v_exp_f32 v152, v152
    v_exp_f32 v153, v153
    v_exp_f32 v154, v154
    v_smfmac_f32_32x32x32_bf16 v[112:127], v[40:43], v[144:151], v5
    ds_read_b128 v[16:19], v2 offset:14336
    v_exp_f32 v155, v155
    v_exp_f32 v156, v156
    v_exp_f32 v157, v157
    v_exp_f32 v158, v158
    v_exp_f32 v159, v159
    s_setprio 1
    v_exp_f32 v128, v128
    v_exp_f32 v129, v129
    v_smfmac_f32_32x32x32_bf16 v[112:127], v[44:47], v[152:159], v5
    ds_read_b64_tr_b16 v[40:41], v3 offset:6144
    v_exp_f32 v130, v130
    v_exp_f32 v131, v131
    v_exp_f32 v132, v132
    v_mfma_f32_32x32x16_bf16 v[144:159], v[20:23], v[12:15], 4.0
    ds_read_b64_tr_b16 v[42:43], v3 offset:6272
    v_exp_f32 v133, v133
    v_exp_f32 v134, v134
    v_exp_f32 v135, v135
    v_exp_f32 v136, v136
    v_exp_f32 v137, v137
    v_exp_f32 v138, v138
    v_smfmac_f32_32x32x32_bf16 v[96:111], v[48:51], v[128:135], v5
    v_exp_f32 v139, v139
    v_exp_f32 v140, v140
    s_add_u32 s28, s28, 8192
    s_add_u32 m0, s29, 40960
    v_exp_f32 v141, v141
    buffer_load_dwordx4 v7, s[12:15], s28 offen lds
    v_exp_f32 v142, v142
    v_exp_f32 v143, v143
    s_waitcnt lgkmcnt(0)
    v_exp_f32 v144, v144
    v_exp_f32 v145, v145
    v_smfmac_f32_32x32x32_bf16 v[96:111], v[52:55], v[136:143], v5
    ds_read_b64_tr_b16 v[44:45], v3 offset:6656
    v_exp_f32 v146, v146
    v_exp_f32 v147, v147
    v_exp_f32 v148, v148
    v_mfma_f32_32x32x16_bf16 v[128:143], v[16:19], v[8:11], 4.0
    ds_read_b64_tr_b16 v[46:47], v3 offset:6784
    v_exp_f32 v149, v149
    v_exp_f32 v150, v150
    v_exp_f32 v151, v151
    v_exp_f32 v152, v152
    v_exp_f32 v153, v153
    v_exp_f32 v154, v154
    v_smfmac_f32_32x32x32_bf16 v[112:127], v[48:51], v[144:151], v5
    ds_read_b128 v[20:23], v2 offset:15360
    v_exp_f32 v155, v155
    v_exp_f32 v156, v156
    v_exp_f32 v157, v157
    v_exp_f32 v158, v158
    v_exp_f32 v159, v159
    s_setprio 0
    v_exp_f32 v128, v128
    v_exp_f32 v129, v129
    v_smfmac_f32_32x32x32_bf16 v[112:127], v[52:55], v[152:159], v5
    ds_read_b64_tr_b16 v[48:49], v3 offset:7168
    v_exp_f32 v130, v130
    v_exp_f32 v131, v131
    v_exp_f32 v132, v132
    v_mfma_f32_32x32x16_bf16 v[144:159], v[16:19], v[12:15], 4.0
    ds_read_b64_tr_b16 v[50:51], v3 offset:7296
    v_exp_f32 v133, v133
    v_exp_f32 v134, v134
    v_exp_f32 v135, v135
    v_exp_f32 v136, v136
    v_exp_f32 v137, v137
    v_exp_f32 v138, v138
    v_smfmac_f32_32x32x32_bf16 v[96:111], v[40:43], v[128:135], v5
    v_exp_f32 v139, v139
    v_exp_f32 v140, v140
    v_exp_f32 v141, v141
    v_exp_f32 v142, v142
    v_exp_f32 v143, v143
    s_waitcnt vmcnt(3) lgkmcnt(0)
    s_barrier
    s_setprio 3
    v_exp_f32 v144, v144
    v_exp_f32 v145, v145
    v_smfmac_f32_32x32x32_bf16 v[96:111], v[44:47], v[136:143], v5
    ds_read_b64_tr_b16 v[52:53], v3 offset:7680
    v_exp_f32 v146, v146
    v_exp_f32 v147, v147
    v_exp_f32 v148, v148
    v_mfma_f32_32x32x16_bf16 v[128:143], v[20:23], v[8:11], 4.0
    ds_read_b64_tr_b16 v[54:55], v3 offset:7808
    v_exp_f32 v149, v149
    v_exp_f32 v150, v150
    v_exp_f32 v151, v151
    v_exp_f32 v152, v152
    v_exp_f32 v153, v153
    v_exp_f32 v154, v154
    v_smfmac_f32_32x32x32_bf16 v[112:127], v[40:43], v[144:151], v5
    ds_read_b128 v[16:19], v2 offset:16384
    v_exp_f32 v155, v155
    v_exp_f32 v156, v156
    s_add_u32 m0, s29, 106496
    v_exp_f32 v157, v157
    buffer_load_dwordx4 v2, s[16:19], s28 offen lds
    v_exp_f32 v158, v158
    v_exp_f32 v159, v159
    v_add_u32 v3, v4, v3
    v_exp_f32 v128, v128
    v_exp_f32 v129, v129
    v_smfmac_f32_32x32x32_bf16 v[112:127], v[44:47], v[152:159], v5
    ds_read_b64_tr_b16 v[40:41], v3 offset:0
    v_exp_f32 v130, v130
    v_exp_f32 v131, v131
    v_exp_f32 v132, v132
    v_mfma_f32_32x32x16_bf16 v[144:159], v[20:23], v[12:15], 4.0
    ds_read_b64_tr_b16 v[42:43], v3 offset:128
    v_exp_f32 v133, v133
    v_exp_f32 v134, v134
    v_exp_f32 v135, v135
    v_exp_f32 v136, v136
    v_exp_f32 v137, v137
    v_exp_f32 v138, v138
    v_smfmac_f32_32x32x32_bf16 v[96:111], v[48:51], v[128:135], v5
    v_exp_f32 v139, v139
    v_exp_f32 v140, v140
    v_exp_f32 v141, v141
    v_exp_f32 v142, v142
    v_exp_f32 v143, v143
    s_waitcnt lgkmcnt(0)
    v_exp_f32 v144, v144
    v_exp_f32 v145, v145
    v_smfmac_f32_32x32x32_bf16 v[96:111], v[52:55], v[136:143], v5
    ds_read_b64_tr_b16 v[44:45], v3 offset:512
    v_exp_f32 v146, v146
    v_exp_f32 v147, v147
    v_exp_f32 v148, v148
    v_mfma_f32_32x32x16_bf16 v[128:143], v[16:19], v[8:11], 4.0
    ds_read_b64_tr_b16 v[46:47], v3 offset:640
    v_exp_f32 v149, v149
    v_exp_f32 v150, v150
    v_exp_f32 v151, v151
    v_exp_f32 v152, v152
    v_exp_f32 v153, v153
    v_exp_f32 v154, v154
    v_smfmac_f32_32x32x32_bf16 v[112:127], v[48:51], v[144:151], v5
    ds_read_b128 v[20:23], v2 offset:17408
    v_exp_f32 v155, v155
    v_exp_f32 v156, v156
    v_exp_f32 v157, v157
    v_exp_f32 v158, v158
    v_exp_f32 v159, v159
    v_exp_f32 v128, v128
    v_exp_f32 v129, v129
    v_smfmac_f32_32x32x32_bf16 v[112:127], v[52:55], v[152:159], v5
    ds_read_b64_tr_b16 v[48:49], v3 offset:1024
    v_exp_f32 v130, v130
    v_exp_f32 v131, v131
    v_exp_f32 v132, v132
    v_mfma_f32_32x32x16_bf16 v[144:159], v[16:19], v[12:15], 4.0
    ds_read_b64_tr_b16 v[50:51], v3 offset:1152
    v_exp_f32 v133, v133
    v_exp_f32 v134, v134
    v_exp_f32 v135, v135
    v_exp_f32 v136, v136
    v_exp_f32 v137, v137
    v_exp_f32 v138, v138
    v_smfmac_f32_32x32x32_bf16 v[96:111], v[40:43], v[128:135], v5
    v_exp_f32 v139, v139
    v_exp_f32 v140, v140
    s_add_u32 s28, s28, 8192
    s_add_u32 m0, s29, 49152
    v_exp_f32 v141, v141
    buffer_load_dwordx4 v7, s[12:15], s28 offen lds
    v_exp_f32 v142, v142
    v_exp_f32 v143, v143
    s_waitcnt lgkmcnt(0)
    v_exp_f32 v144, v144
    v_exp_f32 v145, v145
    v_smfmac_f32_32x32x32_bf16 v[96:111], v[44:47], v[136:143], v5
    ds_read_b64_tr_b16 v[52:53], v3 offset:1536
    v_exp_f32 v146, v146
    v_exp_f32 v147, v147
    v_exp_f32 v148, v148
    v_mfma_f32_32x32x16_bf16 v[128:143], v[20:23], v[8:11], 4.0
    ds_read_b64_tr_b16 v[54:55], v3 offset:1664
    v_exp_f32 v149, v149
    v_exp_f32 v150, v150
    v_exp_f32 v151, v151
    v_exp_f32 v152, v152
    v_exp_f32 v153, v153
    v_exp_f32 v154, v154
    v_smfmac_f32_32x32x32_bf16 v[112:127], v[40:43], v[144:151], v5
    ds_read_b128 v[16:19], v2 offset:18432
    v_exp_f32 v155, v155
    v_exp_f32 v156, v156
    v_exp_f32 v157, v157
    v_exp_f32 v158, v158
    v_exp_f32 v159, v159
    v_exp_f32 v128, v128
    v_exp_f32 v129, v129
    v_smfmac_f32_32x32x32_bf16 v[112:127], v[44:47], v[152:159], v5
    ds_read_b64_tr_b16 v[40:41], v3 offset:2048
    v_exp_f32 v130, v130
    v_exp_f32 v131, v131
    v_exp_f32 v132, v132
    v_mfma_f32_32x32x16_bf16 v[144:159], v[20:23], v[12:15], 4.0
    ds_read_b64_tr_b16 v[42:43], v3 offset:2176
    v_exp_f32 v133, v133
    v_exp_f32 v134, v134
    v_exp_f32 v135, v135
    v_exp_f32 v136, v136
    v_exp_f32 v137, v137
    v_exp_f32 v138, v138
    v_smfmac_f32_32x32x32_bf16 v[96:111], v[48:51], v[128:135], v5
    v_exp_f32 v139, v139
    v_exp_f32 v140, v140
    v_exp_f32 v141, v141
    v_exp_f32 v142, v142
    v_exp_f32 v143, v143
    s_waitcnt lgkmcnt(0)
    v_exp_f32 v144, v144
    v_exp_f32 v145, v145
    v_smfmac_f32_32x32x32_bf16 v[96:111], v[52:55], v[136:143], v5
    ds_read_b64_tr_b16 v[44:45], v3 offset:2560
    v_exp_f32 v146, v146
    v_exp_f32 v147, v147
    v_exp_f32 v148, v148
    v_mfma_f32_32x32x16_bf16 v[128:143], v[16:19], v[8:11], 4.0
    ds_read_b64_tr_b16 v[46:47], v3 offset:2688
    v_exp_f32 v149, v149
    v_exp_f32 v150, v150
    v_exp_f32 v151, v151
    v_exp_f32 v152, v152
    v_exp_f32 v153, v153
    v_exp_f32 v154, v154
    v_smfmac_f32_32x32x32_bf16 v[112:127], v[48:51], v[144:151], v5
    ds_read_b128 v[20:23], v2 offset:19456
    v_exp_f32 v155, v155
    v_exp_f32 v156, v156
    s_add_u32 m0, s29, 114688
    v_exp_f32 v157, v157
    buffer_load_dwordx4 v2, s[16:19], s28 offen lds
    v_exp_f32 v158, v158
    v_exp_f32 v159, v159
    v_exp_f32 v128, v128
    v_exp_f32 v129, v129
    v_smfmac_f32_32x32x32_bf16 v[112:127], v[52:55], v[152:159], v5
    ds_read_b64_tr_b16 v[48:49], v3 offset:3072
    v_exp_f32 v130, v130
    v_exp_f32 v131, v131
    v_exp_f32 v132, v132
    v_mfma_f32_32x32x16_bf16 v[144:159], v[16:19], v[12:15], 4.0
    ds_read_b64_tr_b16 v[50:51], v3 offset:3200
    v_exp_f32 v133, v133
    v_exp_f32 v134, v134
    v_exp_f32 v135, v135
    v_exp_f32 v136, v136
    v_exp_f32 v137, v137
    v_exp_f32 v138, v138
    v_smfmac_f32_32x32x32_bf16 v[96:111], v[40:43], v[128:135], v5
    v_exp_f32 v139, v139
    v_exp_f32 v140, v140
    v_exp_f32 v141, v141
    v_exp_f32 v142, v142
    v_exp_f32 v143, v143
    s_waitcnt lgkmcnt(0)
    v_exp_f32 v144, v144
    v_exp_f32 v145, v145
    v_smfmac_f32_32x32x32_bf16 v[96:111], v[44:47], v[136:143], v5
    ds_read_b64_tr_b16 v[52:53], v3 offset:3584
    v_exp_f32 v146, v146
    v_exp_f32 v147, v147
    v_exp_f32 v148, v148
    v_mfma_f32_32x32x16_bf16 v[128:143], v[20:23], v[8:11], 4.0
    ds_read_b64_tr_b16 v[54:55], v3 offset:3712
    v_exp_f32 v149, v149
    v_exp_f32 v150, v150
    v_exp_f32 v151, v151
    v_exp_f32 v152, v152
    v_exp_f32 v153, v153
    v_exp_f32 v154, v154
    v_smfmac_f32_32x32x32_bf16 v[112:127], v[40:43], v[144:151], v5
    ds_read_b128 v[16:19], v2 offset:20480
    v_exp_f32 v155, v155
    v_exp_f32 v156, v156
    v_exp_f32 v157, v157
    v_exp_f32 v158, v158
    v_exp_f32 v159, v159
    v_exp_f32 v128, v128
    v_exp_f32 v129, v129
    v_smfmac_f32_32x32x32_bf16 v[112:127], v[44:47], v[152:159], v5
    ds_read_b64_tr_b16 v[40:41], v3 offset:4096
    v_exp_f32 v130, v130
    v_exp_f32 v131, v131
    v_exp_f32 v132, v132
    v_mfma_f32_32x32x16_bf16 v[144:159], v[20:23], v[12:15], 4.0
    ds_read_b64_tr_b16 v[42:43], v3 offset:4224
    v_exp_f32 v133, v133
    v_exp_f32 v134, v134
    v_exp_f32 v135, v135
    v_exp_f32 v136, v136
    v_exp_f32 v137, v137
    v_exp_f32 v138, v138
    v_smfmac_f32_32x32x32_bf16 v[96:111], v[48:51], v[128:135], v5
    v_exp_f32 v139, v139
    v_exp_f32 v140, v140
    s_add_u32 s28, s28, 8192
    s_add_u32 m0, s29, 57344
    v_exp_f32 v141, v141
    buffer_load_dwordx4 v7, s[12:15], s28 offen lds
    v_exp_f32 v142, v142
    v_exp_f32 v143, v143
    s_waitcnt lgkmcnt(0)
    v_exp_f32 v144, v144
    v_exp_f32 v145, v145
    v_smfmac_f32_32x32x32_bf16 v[96:111], v[52:55], v[136:143], v5
    ds_read_b64_tr_b16 v[44:45], v3 offset:4608
    v_exp_f32 v146, v146
    v_exp_f32 v147, v147
    v_exp_f32 v148, v148
    v_mfma_f32_32x32x16_bf16 v[128:143], v[16:19], v[8:11], 4.0
    ds_read_b64_tr_b16 v[46:47], v3 offset:4736
    v_exp_f32 v149, v149
    v_exp_f32 v150, v150
    v_exp_f32 v151, v151
    v_exp_f32 v152, v152
    v_exp_f32 v153, v153
    v_exp_f32 v154, v154
    v_smfmac_f32_32x32x32_bf16 v[112:127], v[48:51], v[144:151], v5
    ds_read_b128 v[20:23], v2 offset:21504
    v_exp_f32 v155, v155
    v_exp_f32 v156, v156
    v_exp_f32 v157, v157
    v_exp_f32 v158, v158
    v_exp_f32 v159, v159
    v_exp_f32 v128, v128
    v_exp_f32 v129, v129
    v_smfmac_f32_32x32x32_bf16 v[112:127], v[52:55], v[152:159], v5
    ds_read_b64_tr_b16 v[48:49], v3 offset:5120
    v_exp_f32 v130, v130
    v_exp_f32 v131, v131
    v_exp_f32 v132, v132
    v_mfma_f32_32x32x16_bf16 v[144:159], v[16:19], v[12:15], 4.0
    ds_read_b64_tr_b16 v[50:51], v3 offset:5248
    v_exp_f32 v133, v133
    v_exp_f32 v134, v134
    v_exp_f32 v135, v135
    v_exp_f32 v136, v136
    v_exp_f32 v137, v137
    v_exp_f32 v138, v138
    v_smfmac_f32_32x32x32_bf16 v[96:111], v[40:43], v[128:135], v5
    v_exp_f32 v139, v139
    v_exp_f32 v140, v140
    v_exp_f32 v141, v141
    v_exp_f32 v142, v142
    v_exp_f32 v143, v143
    s_waitcnt lgkmcnt(0)
    v_exp_f32 v144, v144
    v_exp_f32 v145, v145
    v_smfmac_f32_32x32x32_bf16 v[96:111], v[44:47], v[136:143], v5
    ds_read_b64_tr_b16 v[52:53], v3 offset:5632
    v_exp_f32 v146, v146
    v_exp_f32 v147, v147
    v_exp_f32 v148, v148
    v_mfma_f32_32x32x16_bf16 v[128:143], v[20:23], v[8:11], 4.0
    ds_read_b64_tr_b16 v[54:55], v3 offset:5760
    v_exp_f32 v149, v149
    v_exp_f32 v150, v150
    v_exp_f32 v151, v151
    v_exp_f32 v152, v152
    v_exp_f32 v153, v153
    v_exp_f32 v154, v154
    v_smfmac_f32_32x32x32_bf16 v[112:127], v[40:43], v[144:151], v5
    ds_read_b128 v[16:19], v2 offset:22528
    v_exp_f32 v155, v155
    v_exp_f32 v156, v156
    s_add_u32 m0, s29, 122880
    v_exp_f32 v157, v157
    buffer_load_dwordx4 v2, s[16:19], s28 offen lds
    v_exp_f32 v158, v158
    v_exp_f32 v159, v159
    v_exp_f32 v128, v128
    v_exp_f32 v129, v129
    v_smfmac_f32_32x32x32_bf16 v[112:127], v[44:47], v[152:159], v5
    ds_read_b64_tr_b16 v[40:41], v3 offset:6144
    v_exp_f32 v130, v130
    v_exp_f32 v131, v131
    v_exp_f32 v132, v132
    v_mfma_f32_32x32x16_bf16 v[144:159], v[20:23], v[12:15], 4.0
    ds_read_b64_tr_b16 v[42:43], v3 offset:6272
    v_exp_f32 v133, v133
    v_exp_f32 v134, v134
    v_exp_f32 v135, v135
    v_exp_f32 v136, v136
    v_exp_f32 v137, v137
    v_exp_f32 v138, v138
    v_smfmac_f32_32x32x32_bf16 v[96:111], v[48:51], v[128:135], v5
    v_exp_f32 v139, v139
    v_exp_f32 v140, v140
    v_exp_f32 v141, v141
    v_exp_f32 v142, v142
    v_exp_f32 v143, v143
    s_waitcnt lgkmcnt(0)
    v_exp_f32 v144, v144
    v_exp_f32 v145, v145
    v_smfmac_f32_32x32x32_bf16 v[96:111], v[52:55], v[136:143], v5
    ds_read_b64_tr_b16 v[44:45], v3 offset:6656
    v_exp_f32 v146, v146
    v_exp_f32 v147, v147
    v_exp_f32 v148, v148
    v_mfma_f32_32x32x16_bf16 v[128:143], v[16:19], v[8:11], 4.0
    ds_read_b64_tr_b16 v[46:47], v3 offset:6784
    v_exp_f32 v149, v149
    v_exp_f32 v150, v150
    v_exp_f32 v151, v151
    v_exp_f32 v152, v152
    v_exp_f32 v153, v153
    v_exp_f32 v154, v154
    v_smfmac_f32_32x32x32_bf16 v[112:127], v[48:51], v[144:151], v5
    ds_read_b128 v[20:23], v2 offset:23552
    v_exp_f32 v155, v155
    v_exp_f32 v156, v156
    v_exp_f32 v157, v157
    v_exp_f32 v158, v158
    v_exp_f32 v159, v159
    v_exp_f32 v128, v128
    v_exp_f32 v129, v129
    v_smfmac_f32_32x32x32_bf16 v[112:127], v[52:55], v[152:159], v5
    ds_read_b64_tr_b16 v[48:49], v3 offset:7168
    v_exp_f32 v130, v130
    v_exp_f32 v131, v131
    v_exp_f32 v132, v132
    v_mfma_f32_32x32x16_bf16 v[144:159], v[16:19], v[12:15], 4.0
    ds_read_b64_tr_b16 v[50:51], v3 offset:7296
    v_exp_f32 v133, v133
    v_exp_f32 v134, v134
    v_exp_f32 v135, v135
    v_exp_f32 v136, v136
    v_exp_f32 v137, v137
    v_exp_f32 v138, v138
    v_smfmac_f32_32x32x32_bf16 v[96:111], v[40:43], v[128:135], v5
    v_exp_f32 v139, v139
    v_exp_f32 v140, v140
    v_exp_f32 v141, v141
    v_exp_f32 v142, v142
    v_exp_f32 v143, v143
    s_waitcnt lgkmcnt(0)
    v_exp_f32 v144, v144
    v_exp_f32 v145, v145
    v_smfmac_f32_32x32x32_bf16 v[96:111], v[44:47], v[136:143], v5
    ds_read_b64_tr_b16 v[52:53], v3 offset:7680
    v_exp_f32 v146, v146
    v_exp_f32 v147, v147
    v_exp_f32 v148, v148
    v_mfma_f32_32x32x16_bf16 v[128:143], v[20:23], v[8:11], 4.0
    ds_read_b64_tr_b16 v[54:55], v3 offset:7808
    v_exp_f32 v149, v149
    v_exp_f32 v150, v150
    v_exp_f32 v151, v151
    v_exp_f32 v152, v152
    v_exp_f32 v153, v153
    v_exp_f32 v154, v154
    v_smfmac_f32_32x32x32_bf16 v[112:127], v[40:43], v[144:151], v5
    ds_read_b128 v[16:19], v2 offset:24576
    v_exp_f32 v155, v155
    v_exp_f32 v156, v156
    v_exp_f32 v157, v157
    v_exp_f32 v158, v158
    v_exp_f32 v159, v159
    v_add_u32 v3, v4, v3
    v_exp_f32 v128, v128
    v_exp_f32 v129, v129
    v_smfmac_f32_32x32x32_bf16 v[112:127], v[44:47], v[152:159], v5
    ds_read_b64_tr_b16 v[40:41], v3 offset:0
    v_exp_f32 v130, v130
    v_exp_f32 v131, v131
    v_exp_f32 v132, v132
    v_mfma_f32_32x32x16_bf16 v[144:159], v[20:23], v[12:15], 4.0
    ds_read_b64_tr_b16 v[42:43], v3 offset:128
    v_exp_f32 v133, v133
    v_exp_f32 v134, v134
    v_exp_f32 v135, v135
    v_exp_f32 v136, v136
    v_exp_f32 v137, v137
    v_exp_f32 v138, v138
    v_smfmac_f32_32x32x32_bf16 v[96:111], v[48:51], v[128:135], v5
    v_exp_f32 v139, v139
    v_exp_f32 v140, v140
    v_exp_f32 v141, v141
    v_exp_f32 v142, v142
    v_exp_f32 v143, v143
    s_waitcnt lgkmcnt(0)
    v_exp_f32 v144, v144
    v_exp_f32 v145, v145
    v_smfmac_f32_32x32x32_bf16 v[96:111], v[52:55], v[136:143], v5
    ds_read_b64_tr_b16 v[44:45], v3 offset:512
    v_exp_f32 v146, v146
    v_exp_f32 v147, v147
    v_exp_f32 v148, v148
    v_mfma_f32_32x32x16_bf16 v[128:143], v[16:19], v[8:11], 4.0
    ds_read_b64_tr_b16 v[46:47], v3 offset:640
    v_exp_f32 v149, v149
    v_exp_f32 v150, v150
    v_exp_f32 v151, v151
    v_exp_f32 v152, v152
    v_exp_f32 v153, v153
    v_exp_f32 v154, v154
    v_smfmac_f32_32x32x32_bf16 v[112:127], v[48:51], v[144:151], v5
    ds_read_b128 v[20:23], v2 offset:25600
    v_exp_f32 v155, v155
    v_exp_f32 v156, v156
    v_exp_f32 v157, v157
    v_exp_f32 v158, v158
    v_exp_f32 v159, v159
    v_exp_f32 v128, v128
    v_exp_f32 v129, v129
    v_smfmac_f32_32x32x32_bf16 v[112:127], v[52:55], v[152:159], v5
    ds_read_b64_tr_b16 v[48:49], v3 offset:1024
    v_exp_f32 v130, v130
    v_exp_f32 v131, v131
    v_exp_f32 v132, v132
    v_mfma_f32_32x32x16_bf16 v[144:159], v[16:19], v[12:15], 4.0
    ds_read_b64_tr_b16 v[50:51], v3 offset:1152
    v_exp_f32 v133, v133
    v_exp_f32 v134, v134
    v_exp_f32 v135, v135
    v_exp_f32 v136, v136
    v_exp_f32 v137, v137
    v_exp_f32 v138, v138
    v_smfmac_f32_32x32x32_bf16 v[96:111], v[40:43], v[128:135], v5
    v_exp_f32 v139, v139
    v_exp_f32 v140, v140
    v_exp_f32 v141, v141
    v_exp_f32 v142, v142
    v_exp_f32 v143, v143
    s_waitcnt lgkmcnt(0)
    v_exp_f32 v144, v144
    v_exp_f32 v145, v145
    v_smfmac_f32_32x32x32_bf16 v[96:111], v[44:47], v[136:143], v5
    ds_read_b64_tr_b16 v[52:53], v3 offset:1536
    v_exp_f32 v146, v146
    v_exp_f32 v147, v147
    v_exp_f32 v148, v148
    v_mfma_f32_32x32x16_bf16 v[128:143], v[20:23], v[8:11], 4.0
    ds_read_b64_tr_b16 v[54:55], v3 offset:1664
    v_exp_f32 v149, v149
    v_exp_f32 v150, v150
    v_exp_f32 v151, v151
    v_exp_f32 v152, v152
    v_exp_f32 v153, v153
    v_exp_f32 v154, v154
    v_smfmac_f32_32x32x32_bf16 v[112:127], v[40:43], v[144:151], v5
    ds_read_b128 v[16:19], v2 offset:26624
    v_exp_f32 v155, v155
    v_exp_f32 v156, v156
    v_exp_f32 v157, v157
    v_exp_f32 v158, v158
    v_exp_f32 v159, v159
    s_setprio 2
    v_exp_f32 v128, v128
    v_exp_f32 v129, v129
    v_smfmac_f32_32x32x32_bf16 v[112:127], v[44:47], v[152:159], v5
    ds_read_b64_tr_b16 v[40:41], v3 offset:2048
    v_exp_f32 v130, v130
    v_exp_f32 v131, v131
    v_exp_f32 v132, v132
    v_mfma_f32_32x32x16_bf16 v[144:159], v[20:23], v[12:15], 4.0
    ds_read_b64_tr_b16 v[42:43], v3 offset:2176
    v_exp_f32 v133, v133
    v_exp_f32 v134, v134
    v_exp_f32 v135, v135
    v_exp_f32 v136, v136
    v_exp_f32 v137, v137
    v_exp_f32 v138, v138
    v_smfmac_f32_32x32x32_bf16 v[96:111], v[48:51], v[128:135], v5
    v_exp_f32 v139, v139
    v_exp_f32 v140, v140
    v_exp_f32 v141, v141
    v_exp_f32 v142, v142
    v_exp_f32 v143, v143
    s_waitcnt lgkmcnt(0)
    v_exp_f32 v144, v144
    v_exp_f32 v145, v145
    v_smfmac_f32_32x32x32_bf16 v[96:111], v[52:55], v[136:143], v5
    ds_read_b64_tr_b16 v[44:45], v3 offset:2560
    v_exp_f32 v146, v146
    v_exp_f32 v147, v147
    v_exp_f32 v148, v148
    v_mfma_f32_32x32x16_bf16 v[128:143], v[16:19], v[8:11], 4.0
    ds_read_b64_tr_b16 v[46:47], v3 offset:2688
    v_exp_f32 v149, v149
    v_exp_f32 v150, v150
    v_exp_f32 v151, v151
    v_exp_f32 v152, v152
    v_exp_f32 v153, v153
    v_exp_f32 v154, v154
    v_smfmac_f32_32x32x32_bf16 v[112:127], v[48:51], v[144:151], v5
    ds_read_b128 v[20:23], v2 offset:27648
    v_exp_f32 v155, v155
    v_exp_f32 v156, v156
    v_exp_f32 v157, v157
    v_exp_f32 v158, v158
    v_exp_f32 v159, v159
    v_exp_f32 v128, v128
    v_exp_f32 v129, v129
    v_smfmac_f32_32x32x32_bf16 v[112:127], v[52:55], v[152:159], v5
    ds_read_b64_tr_b16 v[48:49], v3 offset:3072
    v_exp_f32 v130, v130
    v_exp_f32 v131, v131
    v_exp_f32 v132, v132
    v_mfma_f32_32x32x16_bf16 v[144:159], v[16:19], v[12:15], 4.0
    ds_read_b64_tr_b16 v[50:51], v3 offset:3200
    v_exp_f32 v133, v133
    v_exp_f32 v134, v134
    v_exp_f32 v135, v135
    v_exp_f32 v136, v136
    v_exp_f32 v137, v137
    v_exp_f32 v138, v138
    v_smfmac_f32_32x32x32_bf16 v[96:111], v[40:43], v[128:135], v5
    v_exp_f32 v139, v139
    v_exp_f32 v140, v140
    v_exp_f32 v141, v141
    v_exp_f32 v142, v142
    v_exp_f32 v143, v143
    s_waitcnt lgkmcnt(0)
    v_exp_f32 v144, v144
    v_exp_f32 v145, v145
    v_smfmac_f32_32x32x32_bf16 v[96:111], v[44:47], v[136:143], v5
    ds_read_b64_tr_b16 v[52:53], v3 offset:3584
    v_exp_f32 v146, v146
    v_exp_f32 v147, v147
    v_exp_f32 v148, v148
    v_mfma_f32_32x32x16_bf16 v[128:143], v[20:23], v[8:11], 4.0
    ds_read_b64_tr_b16 v[54:55], v3 offset:3712
    v_exp_f32 v149, v149
    v_exp_f32 v150, v150
    v_exp_f32 v151, v151
    v_exp_f32 v152, v152
    v_exp_f32 v153, v153
    v_exp_f32 v154, v154
    v_smfmac_f32_32x32x32_bf16 v[112:127], v[40:43], v[144:151], v5
    ds_read_b128 v[16:19], v2 offset:28672
    v_exp_f32 v155, v155
    v_exp_f32 v156, v156
    v_exp_f32 v157, v157
    v_exp_f32 v158, v158
    v_exp_f32 v159, v159
    v_exp_f32 v128, v128
    v_exp_f32 v129, v129
    v_smfmac_f32_32x32x32_bf16 v[112:127], v[44:47], v[152:159], v5
    ds_read_b64_tr_b16 v[40:41], v3 offset:4096
    v_exp_f32 v130, v130
    v_exp_f32 v131, v131
    v_exp_f32 v132, v132
    v_mfma_f32_32x32x16_bf16 v[144:159], v[20:23], v[12:15], 4.0
    ds_read_b64_tr_b16 v[42:43], v3 offset:4224
    v_exp_f32 v133, v133
    v_exp_f32 v134, v134
    v_exp_f32 v135, v135
    v_exp_f32 v136, v136
    v_exp_f32 v137, v137
    v_exp_f32 v138, v138
    v_smfmac_f32_32x32x32_bf16 v[96:111], v[48:51], v[128:135], v5
    v_exp_f32 v139, v139
    v_exp_f32 v140, v140
    v_exp_f32 v141, v141
    v_exp_f32 v142, v142
    v_exp_f32 v143, v143
    s_waitcnt lgkmcnt(0)
    v_exp_f32 v144, v144
    v_exp_f32 v145, v145
    v_smfmac_f32_32x32x32_bf16 v[96:111], v[52:55], v[136:143], v5
    ds_read_b64_tr_b16 v[44:45], v3 offset:4608
    v_exp_f32 v146, v146
    v_exp_f32 v147, v147
    v_exp_f32 v148, v148
    v_mfma_f32_32x32x16_bf16 v[128:143], v[16:19], v[8:11], 4.0
    ds_read_b64_tr_b16 v[46:47], v3 offset:4736
    v_exp_f32 v149, v149
    v_exp_f32 v150, v150
    v_exp_f32 v151, v151
    v_exp_f32 v152, v152
    v_exp_f32 v153, v153
    v_exp_f32 v154, v154
    v_smfmac_f32_32x32x32_bf16 v[112:127], v[48:51], v[144:151], v5
    ds_read_b128 v[20:23], v2 offset:29696
    v_exp_f32 v155, v155
    v_exp_f32 v156, v156
    v_exp_f32 v157, v157
    v_exp_f32 v158, v158
    v_exp_f32 v159, v159
    v_exp_f32 v128, v128
    v_exp_f32 v129, v129
    v_smfmac_f32_32x32x32_bf16 v[112:127], v[52:55], v[152:159], v5
    ds_read_b64_tr_b16 v[48:49], v3 offset:5120
    v_exp_f32 v130, v130
    v_exp_f32 v131, v131
    v_exp_f32 v132, v132
    v_mfma_f32_32x32x16_bf16 v[144:159], v[16:19], v[12:15], 4.0
    ds_read_b64_tr_b16 v[50:51], v3 offset:5248
    v_exp_f32 v133, v133
    v_exp_f32 v134, v134
    v_exp_f32 v135, v135
    v_exp_f32 v136, v136
    v_exp_f32 v137, v137
    v_exp_f32 v138, v138
    v_smfmac_f32_32x32x32_bf16 v[96:111], v[40:43], v[128:135], v5
    v_exp_f32 v139, v139
    v_exp_f32 v140, v140
    v_exp_f32 v141, v141
    v_exp_f32 v142, v142
    v_exp_f32 v143, v143
    s_waitcnt lgkmcnt(0)
    v_exp_f32 v144, v144
    v_exp_f32 v145, v145
    v_smfmac_f32_32x32x32_bf16 v[96:111], v[44:47], v[136:143], v5
    ds_read_b64_tr_b16 v[52:53], v3 offset:5632
    v_exp_f32 v146, v146
    v_exp_f32 v147, v147
    v_exp_f32 v148, v148
    v_mfma_f32_32x32x16_bf16 v[128:143], v[20:23], v[8:11], 4.0
    ds_read_b64_tr_b16 v[54:55], v3 offset:5760
    v_exp_f32 v149, v149
    v_exp_f32 v150, v150
    v_exp_f32 v151, v151
    v_exp_f32 v152, v152
    v_exp_f32 v153, v153
    v_exp_f32 v154, v154
    v_smfmac_f32_32x32x32_bf16 v[112:127], v[40:43], v[144:151], v5
    ds_read_b128 v[16:19], v2 offset:30720
    v_exp_f32 v155, v155
    v_exp_f32 v156, v156
    v_exp_f32 v157, v157
    v_exp_f32 v158, v158
    v_exp_f32 v159, v159
    s_setprio 1
    v_exp_f32 v128, v128
    v_exp_f32 v129, v129
    v_smfmac_f32_32x32x32_bf16 v[112:127], v[44:47], v[152:159], v5
    ds_read_b64_tr_b16 v[40:41], v3 offset:6144
    v_exp_f32 v130, v130
    v_exp_f32 v131, v131
    v_exp_f32 v132, v132
    v_mfma_f32_32x32x16_bf16 v[144:159], v[20:23], v[12:15], 4.0
    ds_read_b64_tr_b16 v[42:43], v3 offset:6272
    v_exp_f32 v133, v133
    v_exp_f32 v134, v134
    v_exp_f32 v135, v135
    v_exp_f32 v136, v136
    v_exp_f32 v137, v137
    v_exp_f32 v138, v138
    v_smfmac_f32_32x32x32_bf16 v[96:111], v[48:51], v[128:135], v5
    v_exp_f32 v139, v139
    v_exp_f32 v140, v140
    v_exp_f32 v141, v141
    v_exp_f32 v142, v142
    v_exp_f32 v143, v143
    s_waitcnt lgkmcnt(0)
    v_exp_f32 v144, v144
    v_exp_f32 v145, v145
    v_smfmac_f32_32x32x32_bf16 v[96:111], v[52:55], v[136:143], v5
    ds_read_b64_tr_b16 v[44:45], v3 offset:6656
    v_exp_f32 v146, v146
    v_exp_f32 v147, v147
    v_exp_f32 v148, v148
    v_mfma_f32_32x32x16_bf16 v[128:143], v[16:19], v[8:11], 4.0
    ds_read_b64_tr_b16 v[46:47], v3 offset:6784
    v_exp_f32 v149, v149
    v_exp_f32 v150, v150
    v_exp_f32 v151, v151
    v_exp_f32 v152, v152
    v_exp_f32 v153, v153
    v_exp_f32 v154, v154
    v_smfmac_f32_32x32x32_bf16 v[112:127], v[48:51], v[144:151], v5
    ds_read_b128 v[20:23], v2 offset:31744
    v_exp_f32 v155, v155
    v_exp_f32 v156, v156
    v_exp_f32 v157, v157
    v_exp_f32 v158, v158
    v_exp_f32 v159, v159
    s_setprio 0
    v_exp_f32 v128, v128
    v_exp_f32 v129, v129
    v_smfmac_f32_32x32x32_bf16 v[112:127], v[52:55], v[152:159], v5
    ds_read_b64_tr_b16 v[48:49], v3 offset:7168
    v_exp_f32 v130, v130
    v_exp_f32 v131, v131
    v_exp_f32 v132, v132
    v_mfma_f32_32x32x16_bf16 v[144:159], v[16:19], v[12:15], 4.0
    ds_read_b64_tr_b16 v[50:51], v3 offset:7296
    v_exp_f32 v133, v133
    v_exp_f32 v134, v134
    v_exp_f32 v135, v135
    v_exp_f32 v136, v136
    v_exp_f32 v137, v137
    v_exp_f32 v138, v138
    v_smfmac_f32_32x32x32_bf16 v[96:111], v[40:43], v[128:135], v5
    v_exp_f32 v139, v139
    v_exp_f32 v140, v140
    v_exp_f32 v141, v141
    v_exp_f32 v142, v142
    v_exp_f32 v143, v143
    s_waitcnt vmcnt(0) lgkmcnt(0)
    s_barrier
    s_setprio 3
    v_exp_f32 v144, v144
    v_exp_f32 v145, v145
    v_smfmac_f32_32x32x32_bf16 v[96:111], v[44:47], v[136:143], v5
    ds_read_b64_tr_b16 v[52:53], v3 offset:7680
    v_exp_f32 v146, v146
    v_exp_f32 v147, v147
    v_exp_f32 v148, v148
    v_mfma_f32_32x32x16_bf16 v[128:143], v[20:23], v[8:11], 4.0
    ds_read_b64_tr_b16 v[54:55], v3 offset:7808
    v_exp_f32 v149, v149
    v_exp_f32 v150, v150
    v_exp_f32 v151, v151
    v_exp_f32 v152, v152
    v_exp_f32 v153, v153
    v_exp_f32 v154, v154
    v_smfmac_f32_32x32x32_bf16 v[112:127], v[40:43], v[144:151], v5
    ds_read_b128 v[16:19], v2 offset:32768
    v_exp_f32 v155, v155
    v_exp_f32 v156, v156
    v_exp_f32 v157, v157
    v_exp_f32 v158, v158
    v_exp_f32 v159, v159
    v_add_u32 v3, v4, v3
    v_exp_f32 v128, v128
    v_exp_f32 v129, v129
    v_smfmac_f32_32x32x32_bf16 v[112:127], v[44:47], v[152:159], v5
    ds_read_b64_tr_b16 v[40:41], v3 offset:0
    v_exp_f32 v130, v130
    v_exp_f32 v131, v131
    v_exp_f32 v132, v132
    v_mfma_f32_32x32x16_bf16 v[144:159], v[20:23], v[12:15], 4.0
    ds_read_b64_tr_b16 v[42:43], v3 offset:128
    v_exp_f32 v133, v133
    v_exp_f32 v134, v134
    v_exp_f32 v135, v135
    v_exp_f32 v136, v136
    v_exp_f32 v137, v137
    v_exp_f32 v138, v138
    v_smfmac_f32_32x32x32_bf16 v[96:111], v[48:51], v[128:135], v5
    v_exp_f32 v139, v139
    v_exp_f32 v140, v140
    v_exp_f32 v141, v141
    v_exp_f32 v142, v142
    v_exp_f32 v143, v143
    s_waitcnt lgkmcnt(0)
    v_exp_f32 v144, v144
    v_exp_f32 v145, v145
    v_smfmac_f32_32x32x32_bf16 v[96:111], v[52:55], v[136:143], v5
    ds_read_b64_tr_b16 v[44:45], v3 offset:512
    v_exp_f32 v146, v146
    v_exp_f32 v147, v147
    v_exp_f32 v148, v148
    v_mfma_f32_32x32x16_bf16 v[128:143], v[16:19], v[8:11], 4.0
    ds_read_b64_tr_b16 v[46:47], v3 offset:640
    v_exp_f32 v149, v149
    v_exp_f32 v150, v150
    v_exp_f32 v151, v151
    v_exp_f32 v152, v152
    v_exp_f32 v153, v153
    v_exp_f32 v154, v154
    v_smfmac_f32_32x32x32_bf16 v[112:127], v[48:51], v[144:151], v5
    ds_read_b128 v[20:23], v2 offset:33792
    v_exp_f32 v155, v155
    v_exp_f32 v156, v156
    v_exp_f32 v157, v157
    v_exp_f32 v158, v158
    v_exp_f32 v159, v159
    v_exp_f32 v128, v128
    v_exp_f32 v129, v129
    v_smfmac_f32_32x32x32_bf16 v[112:127], v[52:55], v[152:159], v5
    ds_read_b64_tr_b16 v[48:49], v3 offset:1024
    v_exp_f32 v130, v130
    v_exp_f32 v131, v131
    v_exp_f32 v132, v132
    v_mfma_f32_32x32x16_bf16 v[144:159], v[16:19], v[12:15], 4.0
    ds_read_b64_tr_b16 v[50:51], v3 offset:1152
    v_exp_f32 v133, v133
    v_exp_f32 v134, v134
    v_exp_f32 v135, v135
    v_exp_f32 v136, v136
    v_exp_f32 v137, v137
    v_exp_f32 v138, v138
    v_smfmac_f32_32x32x32_bf16 v[96:111], v[40:43], v[128:135], v5
    v_exp_f32 v139, v139
    v_exp_f32 v140, v140
    v_exp_f32 v141, v141
    v_exp_f32 v142, v142
    v_exp_f32 v143, v143
    s_waitcnt lgkmcnt(0)
    v_exp_f32 v144, v144
    v_exp_f32 v145, v145
    v_smfmac_f32_32x32x32_bf16 v[96:111], v[44:47], v[136:143], v5
    ds_read_b64_tr_b16 v[52:53], v3 offset:1536
    v_exp_f32 v146, v146
    v_exp_f32 v147, v147
    v_exp_f32 v148, v148
    v_mfma_f32_32x32x16_bf16 v[128:143], v[20:23], v[8:11], 4.0
    ds_read_b64_tr_b16 v[54:55], v3 offset:1664
    v_exp_f32 v149, v149
    v_exp_f32 v150, v150
    v_exp_f32 v151, v151
    v_exp_f32 v152, v152
    v_exp_f32 v153, v153
    v_exp_f32 v154, v154
    v_smfmac_f32_32x32x32_bf16 v[112:127], v[40:43], v[144:151], v5
    ds_read_b128 v[16:19], v2 offset:34816
    v_exp_f32 v155, v155
    v_exp_f32 v156, v156
    v_exp_f32 v157, v157
    v_exp_f32 v158, v158
    v_exp_f32 v159, v159
    v_exp_f32 v128, v128
    v_exp_f32 v129, v129
    v_smfmac_f32_32x32x32_bf16 v[112:127], v[44:47], v[152:159], v5
    ds_read_b64_tr_b16 v[40:41], v3 offset:2048
    v_exp_f32 v130, v130
    v_exp_f32 v131, v131
    v_exp_f32 v132, v132
    v_mfma_f32_32x32x16_bf16 v[144:159], v[20:23], v[12:15], 4.0
    ds_read_b64_tr_b16 v[42:43], v3 offset:2176
    v_exp_f32 v133, v133
    v_exp_f32 v134, v134
    v_exp_f32 v135, v135
    v_exp_f32 v136, v136
    v_exp_f32 v137, v137
    v_exp_f32 v138, v138
    v_smfmac_f32_32x32x32_bf16 v[96:111], v[48:51], v[128:135], v5
    v_exp_f32 v139, v139
    v_exp_f32 v140, v140
    v_exp_f32 v141, v141
    v_exp_f32 v142, v142
    v_exp_f32 v143, v143
    s_waitcnt lgkmcnt(0)
    v_exp_f32 v144, v144
    v_exp_f32 v145, v145
    v_smfmac_f32_32x32x32_bf16 v[96:111], v[52:55], v[136:143], v5
    ds_read_b64_tr_b16 v[44:45], v3 offset:2560
    v_exp_f32 v146, v146
    v_exp_f32 v147, v147
    v_exp_f32 v148, v148
    v_mfma_f32_32x32x16_bf16 v[128:143], v[16:19], v[8:11], 4.0
    ds_read_b64_tr_b16 v[46:47], v3 offset:2688
    v_exp_f32 v149, v149
    v_exp_f32 v150, v150
    v_exp_f32 v151, v151
    v_exp_f32 v152, v152
    v_exp_f32 v153, v153
    v_exp_f32 v154, v154
    v_smfmac_f32_32x32x32_bf16 v[112:127], v[48:51], v[144:151], v5
    ds_read_b128 v[20:23], v2 offset:35840
    v_exp_f32 v155, v155
    v_exp_f32 v156, v156
    v_exp_f32 v157, v157
    v_exp_f32 v158, v158
    v_exp_f32 v159, v159
    v_exp_f32 v128, v128
    v_exp_f32 v129, v129
    v_smfmac_f32_32x32x32_bf16 v[112:127], v[52:55], v[152:159], v5
    ds_read_b64_tr_b16 v[48:49], v3 offset:3072
    v_exp_f32 v130, v130
    v_exp_f32 v131, v131
    v_exp_f32 v132, v132
    v_mfma_f32_32x32x16_bf16 v[144:159], v[16:19], v[12:15], 4.0
    ds_read_b64_tr_b16 v[50:51], v3 offset:3200
    v_exp_f32 v133, v133
    v_exp_f32 v134, v134
    v_exp_f32 v135, v135
    v_exp_f32 v136, v136
    v_exp_f32 v137, v137
    v_exp_f32 v138, v138
    v_smfmac_f32_32x32x32_bf16 v[96:111], v[40:43], v[128:135], v5
    v_exp_f32 v139, v139
    v_exp_f32 v140, v140
    v_exp_f32 v141, v141
    v_exp_f32 v142, v142
    v_exp_f32 v143, v143
    s_waitcnt lgkmcnt(0)
    v_exp_f32 v144, v144
    v_exp_f32 v145, v145
    v_smfmac_f32_32x32x32_bf16 v[96:111], v[44:47], v[136:143], v5
    ds_read_b64_tr_b16 v[52:53], v3 offset:3584
    v_exp_f32 v146, v146
    v_exp_f32 v147, v147
    v_exp_f32 v148, v148
    v_mfma_f32_32x32x16_bf16 v[128:143], v[20:23], v[8:11], 4.0
    ds_read_b64_tr_b16 v[54:55], v3 offset:3712
    v_exp_f32 v149, v149
    v_exp_f32 v150, v150
    v_exp_f32 v151, v151
    v_exp_f32 v152, v152
    v_exp_f32 v153, v153
    v_exp_f32 v154, v154
    v_smfmac_f32_32x32x32_bf16 v[112:127], v[40:43], v[144:151], v5
    ds_read_b128 v[16:19], v2 offset:36864
    v_exp_f32 v155, v155
    v_exp_f32 v156, v156
    v_exp_f32 v157, v157
    v_exp_f32 v158, v158
    v_exp_f32 v159, v159
    v_exp_f32 v128, v128
    v_exp_f32 v129, v129
    v_smfmac_f32_32x32x32_bf16 v[112:127], v[44:47], v[152:159], v5
    ds_read_b64_tr_b16 v[40:41], v3 offset:4096
    v_exp_f32 v130, v130
    v_exp_f32 v131, v131
    v_exp_f32 v132, v132
    v_mfma_f32_32x32x16_bf16 v[144:159], v[20:23], v[12:15], 4.0
    ds_read_b64_tr_b16 v[42:43], v3 offset:4224
    v_exp_f32 v133, v133
    v_exp_f32 v134, v134
    v_exp_f32 v135, v135
    v_exp_f32 v136, v136
    v_exp_f32 v137, v137
    v_exp_f32 v138, v138
    v_smfmac_f32_32x32x32_bf16 v[96:111], v[48:51], v[128:135], v5
    v_exp_f32 v139, v139
    v_exp_f32 v140, v140
    v_exp_f32 v141, v141
    v_exp_f32 v142, v142
    v_exp_f32 v143, v143
    s_waitcnt lgkmcnt(0)
    v_exp_f32 v144, v144
    v_exp_f32 v145, v145
    v_smfmac_f32_32x32x32_bf16 v[96:111], v[52:55], v[136:143], v5
    ds_read_b64_tr_b16 v[44:45], v3 offset:4608
    v_exp_f32 v146, v146
    v_exp_f32 v147, v147
    v_exp_f32 v148, v148
    v_mfma_f32_32x32x16_bf16 v[128:143], v[16:19], v[8:11], 4.0
    ds_read_b64_tr_b16 v[46:47], v3 offset:4736
    v_exp_f32 v149, v149
    v_exp_f32 v150, v150
    v_exp_f32 v151, v151
    v_exp_f32 v152, v152
    v_exp_f32 v153, v153
    v_exp_f32 v154, v154
    v_smfmac_f32_32x32x32_bf16 v[112:127], v[48:51], v[144:151], v5
    ds_read_b128 v[20:23], v2 offset:37888
    v_exp_f32 v155, v155
    v_exp_f32 v156, v156
    v_exp_f32 v157, v157
    v_exp_f32 v158, v158
    v_exp_f32 v159, v159
    v_exp_f32 v128, v128
    v_exp_f32 v129, v129
    v_smfmac_f32_32x32x32_bf16 v[112:127], v[52:55], v[152:159], v5
    ds_read_b64_tr_b16 v[48:49], v3 offset:5120
    v_exp_f32 v130, v130
    v_exp_f32 v131, v131
    v_exp_f32 v132, v132
    v_mfma_f32_32x32x16_bf16 v[144:159], v[16:19], v[12:15], 4.0
    ds_read_b64_tr_b16 v[50:51], v3 offset:5248
    v_exp_f32 v133, v133
    v_exp_f32 v134, v134
    v_exp_f32 v135, v135
    v_exp_f32 v136, v136
    v_exp_f32 v137, v137
    v_exp_f32 v138, v138
    v_smfmac_f32_32x32x32_bf16 v[96:111], v[40:43], v[128:135], v5
    v_exp_f32 v139, v139
    v_exp_f32 v140, v140
    v_exp_f32 v141, v141
    v_exp_f32 v142, v142
    v_exp_f32 v143, v143
    s_waitcnt lgkmcnt(0)
    v_exp_f32 v144, v144
    v_exp_f32 v145, v145
    v_smfmac_f32_32x32x32_bf16 v[96:111], v[44:47], v[136:143], v5
    ds_read_b64_tr_b16 v[52:53], v3 offset:5632
    v_exp_f32 v146, v146
    v_exp_f32 v147, v147
    v_exp_f32 v148, v148
    v_mfma_f32_32x32x16_bf16 v[128:143], v[20:23], v[8:11], 4.0
    ds_read_b64_tr_b16 v[54:55], v3 offset:5760
    v_exp_f32 v149, v149
    v_exp_f32 v150, v150
    v_exp_f32 v151, v151
    v_exp_f32 v152, v152
    v_exp_f32 v153, v153
    v_exp_f32 v154, v154
    v_smfmac_f32_32x32x32_bf16 v[112:127], v[40:43], v[144:151], v5
    ds_read_b128 v[16:19], v2 offset:38912
    v_exp_f32 v155, v155
    v_exp_f32 v156, v156
    v_exp_f32 v157, v157
    v_exp_f32 v158, v158
    v_exp_f32 v159, v159
    v_exp_f32 v128, v128
    v_exp_f32 v129, v129
    v_smfmac_f32_32x32x32_bf16 v[112:127], v[44:47], v[152:159], v5
    ds_read_b64_tr_b16 v[40:41], v3 offset:6144
    v_exp_f32 v130, v130
    v_exp_f32 v131, v131
    v_exp_f32 v132, v132
    v_mfma_f32_32x32x16_bf16 v[144:159], v[20:23], v[12:15], 4.0
    ds_read_b64_tr_b16 v[42:43], v3 offset:6272
    v_exp_f32 v133, v133
    v_exp_f32 v134, v134
    v_exp_f32 v135, v135
    v_exp_f32 v136, v136
    v_exp_f32 v137, v137
    v_exp_f32 v138, v138
    v_smfmac_f32_32x32x32_bf16 v[96:111], v[48:51], v[128:135], v5
    v_exp_f32 v139, v139
    v_exp_f32 v140, v140
    v_exp_f32 v141, v141
    v_exp_f32 v142, v142
    v_exp_f32 v143, v143
    s_waitcnt lgkmcnt(0)
    v_exp_f32 v144, v144
    v_exp_f32 v145, v145
    v_smfmac_f32_32x32x32_bf16 v[96:111], v[52:55], v[136:143], v5
    ds_read_b64_tr_b16 v[44:45], v3 offset:6656
    v_exp_f32 v146, v146
    v_exp_f32 v147, v147
    v_exp_f32 v148, v148
    v_mfma_f32_32x32x16_bf16 v[128:143], v[16:19], v[8:11], 4.0
    ds_read_b64_tr_b16 v[46:47], v3 offset:6784
    v_exp_f32 v149, v149
    v_exp_f32 v150, v150
    v_exp_f32 v151, v151
    v_exp_f32 v152, v152
    v_exp_f32 v153, v153
    v_exp_f32 v154, v154
    v_smfmac_f32_32x32x32_bf16 v[112:127], v[48:51], v[144:151], v5
    ds_read_b128 v[20:23], v2 offset:39936
    v_exp_f32 v155, v155
    v_exp_f32 v156, v156
    v_exp_f32 v157, v157
    v_exp_f32 v158, v158
    v_exp_f32 v159, v159
    v_exp_f32 v128, v128
    v_exp_f32 v129, v129
    v_smfmac_f32_32x32x32_bf16 v[112:127], v[52:55], v[152:159], v5
    ds_read_b64_tr_b16 v[48:49], v3 offset:7168
    v_exp_f32 v130, v130
    v_exp_f32 v131, v131
    v_exp_f32 v132, v132
    v_mfma_f32_32x32x16_bf16 v[144:159], v[16:19], v[12:15], 4.0
    ds_read_b64_tr_b16 v[50:51], v3 offset:7296
    v_exp_f32 v133, v133
    v_exp_f32 v134, v134
    v_exp_f32 v135, v135
    v_exp_f32 v136, v136
    v_exp_f32 v137, v137
    v_exp_f32 v138, v138
    v_smfmac_f32_32x32x32_bf16 v[96:111], v[40:43], v[128:135], v5
    v_exp_f32 v139, v139
    v_exp_f32 v140, v140
    v_exp_f32 v141, v141
    v_exp_f32 v142, v142
    v_exp_f32 v143, v143
    s_waitcnt lgkmcnt(0)
    v_exp_f32 v144, v144
    v_exp_f32 v145, v145
    v_smfmac_f32_32x32x32_bf16 v[96:111], v[44:47], v[136:143], v5
    ds_read_b64_tr_b16 v[52:53], v3 offset:7680
    v_exp_f32 v146, v146
    v_exp_f32 v147, v147
    v_exp_f32 v148, v148
    v_mfma_f32_32x32x16_bf16 v[128:143], v[20:23], v[8:11], 4.0
    ds_read_b64_tr_b16 v[54:55], v3 offset:7808
    v_exp_f32 v149, v149
    v_exp_f32 v150, v150
    v_exp_f32 v151, v151
    v_exp_f32 v152, v152
    v_exp_f32 v153, v153
    v_exp_f32 v154, v154
    v_smfmac_f32_32x32x32_bf16 v[112:127], v[40:43], v[144:151], v5
    ds_read_b128 v[16:19], v2 offset:40960
    v_exp_f32 v155, v155
    v_exp_f32 v156, v156
    v_exp_f32 v157, v157
    v_exp_f32 v158, v158
    v_exp_f32 v159, v159
    v_add_u32 v3, v4, v3
    v_exp_f32 v128, v128
    v_exp_f32 v129, v129
    v_smfmac_f32_32x32x32_bf16 v[112:127], v[44:47], v[152:159], v5
    ds_read_b64_tr_b16 v[40:41], v3 offset:0
    v_exp_f32 v130, v130
    v_exp_f32 v131, v131
    v_exp_f32 v132, v132
    v_mfma_f32_32x32x16_bf16 v[144:159], v[20:23], v[12:15], 4.0
    ds_read_b64_tr_b16 v[42:43], v3 offset:128
    v_exp_f32 v133, v133
    v_exp_f32 v134, v134
    v_exp_f32 v135, v135
    v_exp_f32 v136, v136
    v_exp_f32 v137, v137
    v_exp_f32 v138, v138
    v_smfmac_f32_32x32x32_bf16 v[96:111], v[48:51], v[128:135], v5
    v_exp_f32 v139, v139
    v_exp_f32 v140, v140
    v_exp_f32 v141, v141
    v_exp_f32 v142, v142
    v_exp_f32 v143, v143
    s_waitcnt lgkmcnt(0)
    v_exp_f32 v144, v144
    v_exp_f32 v145, v145
    v_smfmac_f32_32x32x32_bf16 v[96:111], v[52:55], v[136:143], v5
    ds_read_b64_tr_b16 v[44:45], v3 offset:512
    v_exp_f32 v146, v146
    v_exp_f32 v147, v147
    v_exp_f32 v148, v148
    v_mfma_f32_32x32x16_bf16 v[128:143], v[16:19], v[8:11], 4.0
    ds_read_b64_tr_b16 v[46:47], v3 offset:640
    v_exp_f32 v149, v149
    v_exp_f32 v150, v150
    v_exp_f32 v151, v151
    v_exp_f32 v152, v152
    v_exp_f32 v153, v153
    v_exp_f32 v154, v154
    v_smfmac_f32_32x32x32_bf16 v[112:127], v[48:51], v[144:151], v5
    ds_read_b128 v[20:23], v2 offset:41984
    v_exp_f32 v155, v155
    v_exp_f32 v156, v156
    v_exp_f32 v157, v157
    v_exp_f32 v158, v158
    v_exp_f32 v159, v159
    v_exp_f32 v128, v128
    v_exp_f32 v129, v129
    v_smfmac_f32_32x32x32_bf16 v[112:127], v[52:55], v[152:159], v5
    ds_read_b64_tr_b16 v[48:49], v3 offset:1024
    v_exp_f32 v130, v130
    v_exp_f32 v131, v131
    v_exp_f32 v132, v132
    v_mfma_f32_32x32x16_bf16 v[144:159], v[16:19], v[12:15], 4.0
    ds_read_b64_tr_b16 v[50:51], v3 offset:1152
    v_exp_f32 v133, v133
    v_exp_f32 v134, v134
    v_exp_f32 v135, v135
    v_exp_f32 v136, v136
    v_exp_f32 v137, v137
    v_exp_f32 v138, v138
    v_smfmac_f32_32x32x32_bf16 v[96:111], v[40:43], v[128:135], v5
    v_exp_f32 v139, v139
    v_exp_f32 v140, v140
    v_exp_f32 v141, v141
    v_exp_f32 v142, v142
    v_exp_f32 v143, v143
    s_waitcnt lgkmcnt(0)
    v_exp_f32 v144, v144
    v_exp_f32 v145, v145
    v_smfmac_f32_32x32x32_bf16 v[96:111], v[44:47], v[136:143], v5
    ds_read_b64_tr_b16 v[52:53], v3 offset:1536
    v_exp_f32 v146, v146
    v_exp_f32 v147, v147
    v_exp_f32 v148, v148
    v_mfma_f32_32x32x16_bf16 v[128:143], v[20:23], v[8:11], 4.0
    ds_read_b64_tr_b16 v[54:55], v3 offset:1664
    v_exp_f32 v149, v149
    v_exp_f32 v150, v150
    v_exp_f32 v151, v151
    v_exp_f32 v152, v152
    v_exp_f32 v153, v153
    v_exp_f32 v154, v154
    v_smfmac_f32_32x32x32_bf16 v[112:127], v[40:43], v[144:151], v5
    ds_read_b128 v[16:19], v2 offset:43008
    v_exp_f32 v155, v155
    v_exp_f32 v156, v156
    v_exp_f32 v157, v157
    v_exp_f32 v158, v158
    v_exp_f32 v159, v159
    v_exp_f32 v128, v128
    v_exp_f32 v129, v129
    v_smfmac_f32_32x32x32_bf16 v[112:127], v[44:47], v[152:159], v5
    ds_read_b64_tr_b16 v[40:41], v3 offset:2048
    v_exp_f32 v130, v130
    v_exp_f32 v131, v131
    v_exp_f32 v132, v132
    v_mfma_f32_32x32x16_bf16 v[144:159], v[20:23], v[12:15], 4.0
    ds_read_b64_tr_b16 v[42:43], v3 offset:2176
    v_exp_f32 v133, v133
    v_exp_f32 v134, v134
    v_exp_f32 v135, v135
    v_exp_f32 v136, v136
    v_exp_f32 v137, v137
    v_exp_f32 v138, v138
    v_smfmac_f32_32x32x32_bf16 v[96:111], v[48:51], v[128:135], v5
    v_exp_f32 v139, v139
    v_exp_f32 v140, v140
    v_exp_f32 v141, v141
    v_exp_f32 v142, v142
    v_exp_f32 v143, v143
    s_waitcnt lgkmcnt(0)
    v_exp_f32 v144, v144
    v_exp_f32 v145, v145
    v_smfmac_f32_32x32x32_bf16 v[96:111], v[52:55], v[136:143], v5
    ds_read_b64_tr_b16 v[44:45], v3 offset:2560
    v_exp_f32 v146, v146
    v_exp_f32 v147, v147
    v_exp_f32 v148, v148
    v_mfma_f32_32x32x16_bf16 v[128:143], v[16:19], v[8:11], 4.0
    ds_read_b64_tr_b16 v[46:47], v3 offset:2688
    v_exp_f32 v149, v149
    v_exp_f32 v150, v150
    v_exp_f32 v151, v151
    v_exp_f32 v152, v152
    v_exp_f32 v153, v153
    v_exp_f32 v154, v154
    v_smfmac_f32_32x32x32_bf16 v[112:127], v[48:51], v[144:151], v5
    ds_read_b128 v[20:23], v2 offset:44032
    v_exp_f32 v155, v155
    v_exp_f32 v156, v156
    v_exp_f32 v157, v157
    v_exp_f32 v158, v158
    v_exp_f32 v159, v159
    v_exp_f32 v128, v128
    v_exp_f32 v129, v129
    v_smfmac_f32_32x32x32_bf16 v[112:127], v[52:55], v[152:159], v5
    ds_read_b64_tr_b16 v[48:49], v3 offset:3072
    v_exp_f32 v130, v130
    v_exp_f32 v131, v131
    v_exp_f32 v132, v132
    v_mfma_f32_32x32x16_bf16 v[144:159], v[16:19], v[12:15], 4.0
    ds_read_b64_tr_b16 v[50:51], v3 offset:3200
    v_exp_f32 v133, v133
    v_exp_f32 v134, v134
    v_exp_f32 v135, v135
    v_exp_f32 v136, v136
    v_exp_f32 v137, v137
    v_exp_f32 v138, v138
    v_smfmac_f32_32x32x32_bf16 v[96:111], v[40:43], v[128:135], v5
    v_exp_f32 v139, v139
    v_exp_f32 v140, v140
    v_exp_f32 v141, v141
    v_exp_f32 v142, v142
    v_exp_f32 v143, v143
    s_waitcnt lgkmcnt(0)
    v_exp_f32 v144, v144
    v_exp_f32 v145, v145
    v_smfmac_f32_32x32x32_bf16 v[96:111], v[44:47], v[136:143], v5
    ds_read_b64_tr_b16 v[52:53], v3 offset:3584
    v_exp_f32 v146, v146
    v_exp_f32 v147, v147
    v_exp_f32 v148, v148
    v_mfma_f32_32x32x16_bf16 v[128:143], v[20:23], v[8:11], 4.0
    ds_read_b64_tr_b16 v[54:55], v3 offset:3712
    v_exp_f32 v149, v149
    v_exp_f32 v150, v150
    v_exp_f32 v151, v151
    v_exp_f32 v152, v152
    v_exp_f32 v153, v153
    v_exp_f32 v154, v154
    v_smfmac_f32_32x32x32_bf16 v[112:127], v[40:43], v[144:151], v5
    ds_read_b128 v[16:19], v2 offset:45056
    v_exp_f32 v155, v155
    v_exp_f32 v156, v156
    v_exp_f32 v157, v157
    v_exp_f32 v158, v158
    v_exp_f32 v159, v159
    v_exp_f32 v128, v128
    v_exp_f32 v129, v129
    v_smfmac_f32_32x32x32_bf16 v[112:127], v[44:47], v[152:159], v5
    ds_read_b64_tr_b16 v[40:41], v3 offset:4096
    v_exp_f32 v130, v130
    v_exp_f32 v131, v131
    v_exp_f32 v132, v132
    v_mfma_f32_32x32x16_bf16 v[144:159], v[20:23], v[12:15], 4.0
    ds_read_b64_tr_b16 v[42:43], v3 offset:4224
    v_exp_f32 v133, v133
    v_exp_f32 v134, v134
    v_exp_f32 v135, v135
    v_exp_f32 v136, v136
    v_exp_f32 v137, v137
    v_exp_f32 v138, v138
    v_smfmac_f32_32x32x32_bf16 v[96:111], v[48:51], v[128:135], v5
    v_exp_f32 v139, v139
    v_exp_f32 v140, v140
    v_exp_f32 v141, v141
    v_exp_f32 v142, v142
    v_exp_f32 v143, v143
    s_waitcnt lgkmcnt(0)
    v_exp_f32 v144, v144
    v_exp_f32 v145, v145
    v_smfmac_f32_32x32x32_bf16 v[96:111], v[52:55], v[136:143], v5
    ds_read_b64_tr_b16 v[44:45], v3 offset:4608
    v_exp_f32 v146, v146
    v_exp_f32 v147, v147
    v_exp_f32 v148, v148
    v_mfma_f32_32x32x16_bf16 v[128:143], v[16:19], v[8:11], 4.0
    ds_read_b64_tr_b16 v[46:47], v3 offset:4736
    v_exp_f32 v149, v149
    v_exp_f32 v150, v150
    v_exp_f32 v151, v151
    v_exp_f32 v152, v152
    v_exp_f32 v153, v153
    v_exp_f32 v154, v154
    v_smfmac_f32_32x32x32_bf16 v[112:127], v[48:51], v[144:151], v5
    ds_read_b128 v[20:23], v2 offset:46080
    v_exp_f32 v155, v155
    v_exp_f32 v156, v156
    v_exp_f32 v157, v157
    v_exp_f32 v158, v158
    v_exp_f32 v159, v159
    v_exp_f32 v128, v128
    v_exp_f32 v129, v129
    v_smfmac_f32_32x32x32_bf16 v[112:127], v[52:55], v[152:159], v5
    ds_read_b64_tr_b16 v[48:49], v3 offset:5120
    v_exp_f32 v130, v130
    v_exp_f32 v131, v131
    v_exp_f32 v132, v132
    v_mfma_f32_32x32x16_bf16 v[144:159], v[16:19], v[12:15], 4.0
    ds_read_b64_tr_b16 v[50:51], v3 offset:5248
    v_exp_f32 v133, v133
    v_exp_f32 v134, v134
    v_exp_f32 v135, v135
    v_exp_f32 v136, v136
    v_exp_f32 v137, v137
    v_exp_f32 v138, v138
    v_smfmac_f32_32x32x32_bf16 v[96:111], v[40:43], v[128:135], v5
    v_exp_f32 v139, v139
    v_exp_f32 v140, v140
    v_exp_f32 v141, v141
    v_exp_f32 v142, v142
    v_exp_f32 v143, v143
    s_waitcnt lgkmcnt(0)
    v_exp_f32 v144, v144
    v_exp_f32 v145, v145
    v_smfmac_f32_32x32x32_bf16 v[96:111], v[44:47], v[136:143], v5
    ds_read_b64_tr_b16 v[52:53], v3 offset:5632
    v_exp_f32 v146, v146
    v_exp_f32 v147, v147
    v_exp_f32 v148, v148
    v_mfma_f32_32x32x16_bf16 v[128:143], v[20:23], v[8:11], 4.0
    ds_read_b64_tr_b16 v[54:55], v3 offset:5760
    v_exp_f32 v149, v149
    v_exp_f32 v150, v150
    v_exp_f32 v151, v151
    v_exp_f32 v152, v152
    v_exp_f32 v153, v153
    v_exp_f32 v154, v154
    v_smfmac_f32_32x32x32_bf16 v[112:127], v[40:43], v[144:151], v5
    ds_read_b128 v[16:19], v2 offset:47104
    v_exp_f32 v155, v155
    v_exp_f32 v156, v156
    v_exp_f32 v157, v157
    v_exp_f32 v158, v158
    v_exp_f32 v159, v159
    v_exp_f32 v128, v128
    v_exp_f32 v129, v129
    v_smfmac_f32_32x32x32_bf16 v[112:127], v[44:47], v[152:159], v5
    ds_read_b64_tr_b16 v[40:41], v3 offset:6144
    v_exp_f32 v130, v130
    v_exp_f32 v131, v131
    v_exp_f32 v132, v132
    v_mfma_f32_32x32x16_bf16 v[144:159], v[20:23], v[12:15], 4.0
    ds_read_b64_tr_b16 v[42:43], v3 offset:6272
    v_exp_f32 v133, v133
    v_exp_f32 v134, v134
    v_exp_f32 v135, v135
    v_exp_f32 v136, v136
    v_exp_f32 v137, v137
    v_exp_f32 v138, v138
    v_smfmac_f32_32x32x32_bf16 v[96:111], v[48:51], v[128:135], v5
    v_exp_f32 v139, v139
    v_exp_f32 v140, v140
    v_exp_f32 v141, v141
    v_exp_f32 v142, v142
    v_exp_f32 v143, v143
    s_waitcnt lgkmcnt(0)
    v_exp_f32 v144, v144
    v_exp_f32 v145, v145
    v_smfmac_f32_32x32x32_bf16 v[96:111], v[52:55], v[136:143], v5
    ds_read_b64_tr_b16 v[44:45], v3 offset:6656
    v_exp_f32 v146, v146
    v_exp_f32 v147, v147
    v_exp_f32 v148, v148
    v_mfma_f32_32x32x16_bf16 v[128:143], v[16:19], v[8:11], 4.0
    ds_read_b64_tr_b16 v[46:47], v3 offset:6784
    v_exp_f32 v149, v149
    v_exp_f32 v150, v150
    v_exp_f32 v151, v151
    v_exp_f32 v152, v152
    v_exp_f32 v153, v153
    v_exp_f32 v154, v154
    v_smfmac_f32_32x32x32_bf16 v[112:127], v[48:51], v[144:151], v5
    ds_read_b128 v[20:23], v2 offset:48128
    v_exp_f32 v155, v155
    v_exp_f32 v156, v156
    v_exp_f32 v157, v157
    v_exp_f32 v158, v158
    v_exp_f32 v159, v159
    v_exp_f32 v128, v128
    v_exp_f32 v129, v129
    v_smfmac_f32_32x32x32_bf16 v[112:127], v[52:55], v[152:159], v5
    ds_read_b64_tr_b16 v[48:49], v3 offset:7168
    v_exp_f32 v130, v130
    v_exp_f32 v131, v131
    v_exp_f32 v132, v132
    v_mfma_f32_32x32x16_bf16 v[144:159], v[16:19], v[12:15], 4.0
    ds_read_b64_tr_b16 v[50:51], v3 offset:7296
    v_exp_f32 v133, v133
    v_exp_f32 v134, v134
    v_exp_f32 v135, v135
    v_exp_f32 v136, v136
    v_exp_f32 v137, v137
    v_exp_f32 v138, v138
    v_smfmac_f32_32x32x32_bf16 v[96:111], v[40:43], v[128:135], v5
    v_exp_f32 v139, v139
    v_exp_f32 v140, v140
    v_exp_f32 v141, v141
    v_exp_f32 v142, v142
    v_exp_f32 v143, v143
    s_waitcnt lgkmcnt(0)
    v_exp_f32 v144, v144
    v_exp_f32 v145, v145
    v_smfmac_f32_32x32x32_bf16 v[96:111], v[44:47], v[136:143], v5
    ds_read_b64_tr_b16 v[52:53], v3 offset:7680
    v_exp_f32 v146, v146
    v_exp_f32 v147, v147
    v_exp_f32 v148, v148
    v_mfma_f32_32x32x16_bf16 v[128:143], v[20:23], v[8:11], 4.0
    ds_read_b64_tr_b16 v[54:55], v3 offset:7808
    v_exp_f32 v149, v149
    v_exp_f32 v150, v150
    v_exp_f32 v151, v151
    v_exp_f32 v152, v152
    v_exp_f32 v153, v153
    v_exp_f32 v154, v154
    v_smfmac_f32_32x32x32_bf16 v[112:127], v[40:43], v[144:151], v5
    ds_read_b128 v[16:19], v2 offset:49152
    v_exp_f32 v155, v155
    v_exp_f32 v156, v156
    v_exp_f32 v157, v157
    v_exp_f32 v158, v158
    v_exp_f32 v159, v159
    v_add_u32 v3, v4, v3
    v_exp_f32 v128, v128
    v_exp_f32 v129, v129
    v_smfmac_f32_32x32x32_bf16 v[112:127], v[44:47], v[152:159], v5
    ds_read_b64_tr_b16 v[40:41], v3 offset:0
    v_exp_f32 v130, v130
    v_exp_f32 v131, v131
    v_exp_f32 v132, v132
    v_mfma_f32_32x32x16_bf16 v[144:159], v[20:23], v[12:15], 4.0
    ds_read_b64_tr_b16 v[42:43], v3 offset:128
    v_exp_f32 v133, v133
    v_exp_f32 v134, v134
    v_exp_f32 v135, v135
    v_exp_f32 v136, v136
    v_exp_f32 v137, v137
    v_exp_f32 v138, v138
    v_smfmac_f32_32x32x32_bf16 v[96:111], v[48:51], v[128:135], v5
    v_exp_f32 v139, v139
    v_exp_f32 v140, v140
    v_exp_f32 v141, v141
    v_exp_f32 v142, v142
    v_exp_f32 v143, v143
    s_waitcnt lgkmcnt(0)
    v_exp_f32 v144, v144
    v_exp_f32 v145, v145
    v_smfmac_f32_32x32x32_bf16 v[96:111], v[52:55], v[136:143], v5
    ds_read_b64_tr_b16 v[44:45], v3 offset:512
    v_exp_f32 v146, v146
    v_exp_f32 v147, v147
    v_exp_f32 v148, v148
    v_mfma_f32_32x32x16_bf16 v[128:143], v[16:19], v[8:11], 4.0
    ds_read_b64_tr_b16 v[46:47], v3 offset:640
    v_exp_f32 v149, v149
    v_exp_f32 v150, v150
    v_exp_f32 v151, v151
    v_exp_f32 v152, v152
    v_exp_f32 v153, v153
    v_exp_f32 v154, v154
    v_smfmac_f32_32x32x32_bf16 v[112:127], v[48:51], v[144:151], v5
    ds_read_b128 v[20:23], v2 offset:50176
    v_exp_f32 v155, v155
    v_exp_f32 v156, v156
    v_exp_f32 v157, v157
    v_exp_f32 v158, v158
    v_exp_f32 v159, v159
    v_exp_f32 v128, v128
    v_exp_f32 v129, v129
    v_smfmac_f32_32x32x32_bf16 v[112:127], v[52:55], v[152:159], v5
    ds_read_b64_tr_b16 v[48:49], v3 offset:1024
    v_exp_f32 v130, v130
    v_exp_f32 v131, v131
    v_exp_f32 v132, v132
    v_mfma_f32_32x32x16_bf16 v[144:159], v[16:19], v[12:15], 4.0
    ds_read_b64_tr_b16 v[50:51], v3 offset:1152
    v_exp_f32 v133, v133
    v_exp_f32 v134, v134
    v_exp_f32 v135, v135
    v_exp_f32 v136, v136
    v_exp_f32 v137, v137
    v_exp_f32 v138, v138
    v_smfmac_f32_32x32x32_bf16 v[96:111], v[40:43], v[128:135], v5
    v_exp_f32 v139, v139
    v_exp_f32 v140, v140
    v_exp_f32 v141, v141
    v_exp_f32 v142, v142
    v_exp_f32 v143, v143
    s_waitcnt lgkmcnt(0)
    v_exp_f32 v144, v144
    v_exp_f32 v145, v145
    v_smfmac_f32_32x32x32_bf16 v[96:111], v[44:47], v[136:143], v5
    ds_read_b64_tr_b16 v[52:53], v3 offset:1536
    v_exp_f32 v146, v146
    v_exp_f32 v147, v147
    v_exp_f32 v148, v148
    v_mfma_f32_32x32x16_bf16 v[128:143], v[20:23], v[8:11], 4.0
    ds_read_b64_tr_b16 v[54:55], v3 offset:1664
    v_exp_f32 v149, v149
    v_exp_f32 v150, v150
    v_exp_f32 v151, v151
    v_exp_f32 v152, v152
    v_exp_f32 v153, v153
    v_exp_f32 v154, v154
    v_smfmac_f32_32x32x32_bf16 v[112:127], v[40:43], v[144:151], v5
    ds_read_b128 v[16:19], v2 offset:51200
    v_exp_f32 v155, v155
    v_exp_f32 v156, v156
    v_exp_f32 v157, v157
    v_exp_f32 v158, v158
    v_exp_f32 v159, v159
    v_exp_f32 v128, v128
    v_exp_f32 v129, v129
    v_smfmac_f32_32x32x32_bf16 v[112:127], v[44:47], v[152:159], v5
    ds_read_b64_tr_b16 v[40:41], v3 offset:2048
    v_exp_f32 v130, v130
    v_exp_f32 v131, v131
    v_exp_f32 v132, v132
    v_mfma_f32_32x32x16_bf16 v[144:159], v[20:23], v[12:15], 4.0
    ds_read_b64_tr_b16 v[42:43], v3 offset:2176
    v_exp_f32 v133, v133
    v_exp_f32 v134, v134
    v_exp_f32 v135, v135
    v_exp_f32 v136, v136
    v_exp_f32 v137, v137
    v_exp_f32 v138, v138
    v_smfmac_f32_32x32x32_bf16 v[96:111], v[48:51], v[128:135], v5
    v_exp_f32 v139, v139
    v_exp_f32 v140, v140
    v_exp_f32 v141, v141
    v_exp_f32 v142, v142
    v_exp_f32 v143, v143
    s_waitcnt lgkmcnt(0)
    v_exp_f32 v144, v144
    v_exp_f32 v145, v145
    v_smfmac_f32_32x32x32_bf16 v[96:111], v[52:55], v[136:143], v5
    ds_read_b64_tr_b16 v[44:45], v3 offset:2560
    v_exp_f32 v146, v146
    v_exp_f32 v147, v147
    v_exp_f32 v148, v148
    v_mfma_f32_32x32x16_bf16 v[128:143], v[16:19], v[8:11], 4.0
    ds_read_b64_tr_b16 v[46:47], v3 offset:2688
    v_exp_f32 v149, v149
    v_exp_f32 v150, v150
    v_exp_f32 v151, v151
    v_exp_f32 v152, v152
    v_exp_f32 v153, v153
    v_exp_f32 v154, v154
    v_smfmac_f32_32x32x32_bf16 v[112:127], v[48:51], v[144:151], v5
    ds_read_b128 v[20:23], v2 offset:52224
    v_exp_f32 v155, v155
    v_exp_f32 v156, v156
    v_exp_f32 v157, v157
    v_exp_f32 v158, v158
    v_exp_f32 v159, v159
    v_exp_f32 v128, v128
    v_exp_f32 v129, v129
    v_smfmac_f32_32x32x32_bf16 v[112:127], v[52:55], v[152:159], v5
    ds_read_b64_tr_b16 v[48:49], v3 offset:3072
    v_exp_f32 v130, v130
    v_exp_f32 v131, v131
    v_exp_f32 v132, v132
    v_mfma_f32_32x32x16_bf16 v[144:159], v[16:19], v[12:15], 4.0
    ds_read_b64_tr_b16 v[50:51], v3 offset:3200
    v_exp_f32 v133, v133
    v_exp_f32 v134, v134
    v_exp_f32 v135, v135
    v_exp_f32 v136, v136
    v_exp_f32 v137, v137
    v_exp_f32 v138, v138
    v_smfmac_f32_32x32x32_bf16 v[96:111], v[40:43], v[128:135], v5
    v_exp_f32 v139, v139
    v_exp_f32 v140, v140
    v_exp_f32 v141, v141
    v_exp_f32 v142, v142
    v_exp_f32 v143, v143
    s_waitcnt lgkmcnt(0)
    v_exp_f32 v144, v144
    v_exp_f32 v145, v145
    v_smfmac_f32_32x32x32_bf16 v[96:111], v[44:47], v[136:143], v5
    ds_read_b64_tr_b16 v[52:53], v3 offset:3584
    v_exp_f32 v146, v146
    v_exp_f32 v147, v147
    v_exp_f32 v148, v148
    v_mfma_f32_32x32x16_bf16 v[128:143], v[20:23], v[8:11], 4.0
    ds_read_b64_tr_b16 v[54:55], v3 offset:3712
    v_exp_f32 v149, v149
    v_exp_f32 v150, v150
    v_exp_f32 v151, v151
    v_exp_f32 v152, v152
    v_exp_f32 v153, v153
    v_exp_f32 v154, v154
    v_smfmac_f32_32x32x32_bf16 v[112:127], v[40:43], v[144:151], v5
    ds_read_b128 v[16:19], v2 offset:53248
    v_exp_f32 v155, v155
    v_exp_f32 v156, v156
    v_exp_f32 v157, v157
    v_exp_f32 v158, v158
    v_exp_f32 v159, v159
    v_exp_f32 v128, v128
    v_exp_f32 v129, v129
    v_smfmac_f32_32x32x32_bf16 v[112:127], v[44:47], v[152:159], v5
    ds_read_b64_tr_b16 v[40:41], v3 offset:4096
    v_exp_f32 v130, v130
    v_exp_f32 v131, v131
    v_exp_f32 v132, v132
    v_mfma_f32_32x32x16_bf16 v[144:159], v[20:23], v[12:15], 4.0
    ds_read_b64_tr_b16 v[42:43], v3 offset:4224
    v_exp_f32 v133, v133
    v_exp_f32 v134, v134
    v_exp_f32 v135, v135
    v_exp_f32 v136, v136
    v_exp_f32 v137, v137
    v_exp_f32 v138, v138
    v_smfmac_f32_32x32x32_bf16 v[96:111], v[48:51], v[128:135], v5
    v_exp_f32 v139, v139
    v_exp_f32 v140, v140
    v_exp_f32 v141, v141
    v_exp_f32 v142, v142
    v_exp_f32 v143, v143
    s_waitcnt lgkmcnt(0)
    v_exp_f32 v144, v144
    v_exp_f32 v145, v145
    v_smfmac_f32_32x32x32_bf16 v[96:111], v[52:55], v[136:143], v5
    ds_read_b64_tr_b16 v[44:45], v3 offset:4608
    v_exp_f32 v146, v146
    v_exp_f32 v147, v147
    v_exp_f32 v148, v148
    v_mfma_f32_32x32x16_bf16 v[128:143], v[16:19], v[8:11], 4.0
    ds_read_b64_tr_b16 v[46:47], v3 offset:4736
    v_exp_f32 v149, v149
    v_exp_f32 v150, v150
    v_exp_f32 v151, v151
    v_exp_f32 v152, v152
    v_exp_f32 v153, v153
    v_exp_f32 v154, v154
    v_smfmac_f32_32x32x32_bf16 v[112:127], v[48:51], v[144:151], v5
    ds_read_b128 v[20:23], v2 offset:54272
    v_exp_f32 v155, v155
    v_exp_f32 v156, v156
    v_exp_f32 v157, v157
    v_exp_f32 v158, v158
    v_exp_f32 v159, v159
    v_exp_f32 v128, v128
    v_exp_f32 v129, v129
    v_smfmac_f32_32x32x32_bf16 v[112:127], v[52:55], v[152:159], v5
    ds_read_b64_tr_b16 v[48:49], v3 offset:5120
    v_exp_f32 v130, v130
    v_exp_f32 v131, v131
    v_exp_f32 v132, v132
    v_mfma_f32_32x32x16_bf16 v[144:159], v[16:19], v[12:15], 4.0
    ds_read_b64_tr_b16 v[50:51], v3 offset:5248
    v_exp_f32 v133, v133
    v_exp_f32 v134, v134
    v_exp_f32 v135, v135
    v_exp_f32 v136, v136
    v_exp_f32 v137, v137
    v_exp_f32 v138, v138
    v_smfmac_f32_32x32x32_bf16 v[96:111], v[40:43], v[128:135], v5
    v_exp_f32 v139, v139
    v_exp_f32 v140, v140
    v_exp_f32 v141, v141
    v_exp_f32 v142, v142
    v_exp_f32 v143, v143
    s_waitcnt lgkmcnt(0)
    v_exp_f32 v144, v144
    v_exp_f32 v145, v145
    v_smfmac_f32_32x32x32_bf16 v[96:111], v[44:47], v[136:143], v5
    ds_read_b64_tr_b16 v[52:53], v3 offset:5632
    v_exp_f32 v146, v146
    v_exp_f32 v147, v147
    v_exp_f32 v148, v148
    v_mfma_f32_32x32x16_bf16 v[128:143], v[20:23], v[8:11], 4.0
    ds_read_b64_tr_b16 v[54:55], v3 offset:5760
    v_exp_f32 v149, v149
    v_exp_f32 v150, v150
    v_exp_f32 v151, v151
    v_exp_f32 v152, v152
    v_exp_f32 v153, v153
    v_exp_f32 v154, v154
    v_smfmac_f32_32x32x32_bf16 v[112:127], v[40:43], v[144:151], v5
    ds_read_b128 v[16:19], v2 offset:55296
    v_exp_f32 v155, v155
    v_exp_f32 v156, v156
    v_exp_f32 v157, v157
    v_exp_f32 v158, v158
    v_exp_f32 v159, v159
    v_exp_f32 v128, v128
    v_exp_f32 v129, v129
    v_smfmac_f32_32x32x32_bf16 v[112:127], v[44:47], v[152:159], v5
    ds_read_b64_tr_b16 v[40:41], v3 offset:6144
    v_exp_f32 v130, v130
    v_exp_f32 v131, v131
    v_exp_f32 v132, v132
    v_mfma_f32_32x32x16_bf16 v[144:159], v[20:23], v[12:15], 4.0
    ds_read_b64_tr_b16 v[42:43], v3 offset:6272
    v_exp_f32 v133, v133
    v_exp_f32 v134, v134
    v_exp_f32 v135, v135
    v_exp_f32 v136, v136
    v_exp_f32 v137, v137
    v_exp_f32 v138, v138
    v_smfmac_f32_32x32x32_bf16 v[96:111], v[48:51], v[128:135], v5
    v_exp_f32 v139, v139
    v_exp_f32 v140, v140
    v_exp_f32 v141, v141
    v_exp_f32 v142, v142
    v_exp_f32 v143, v143
    s_waitcnt lgkmcnt(0)
    v_exp_f32 v144, v144
    v_exp_f32 v145, v145
    v_smfmac_f32_32x32x32_bf16 v[96:111], v[52:55], v[136:143], v5
    ds_read_b64_tr_b16 v[44:45], v3 offset:6656
    v_exp_f32 v146, v146
    v_exp_f32 v147, v147
    v_exp_f32 v148, v148
    v_mfma_f32_32x32x16_bf16 v[128:143], v[16:19], v[8:11], 4.0
    ds_read_b64_tr_b16 v[46:47], v3 offset:6784
    v_exp_f32 v149, v149
    v_exp_f32 v150, v150
    v_exp_f32 v151, v151
    v_exp_f32 v152, v152
    v_exp_f32 v153, v153
    v_exp_f32 v154, v154
    v_smfmac_f32_32x32x32_bf16 v[112:127], v[48:51], v[144:151], v5
    ds_read_b128 v[20:23], v2 offset:56320
    v_exp_f32 v155, v155
    v_exp_f32 v156, v156
    v_exp_f32 v157, v157
    v_exp_f32 v158, v158
    v_exp_f32 v159, v159
    s_setprio 2
    v_exp_f32 v128, v128
    v_exp_f32 v129, v129
    v_smfmac_f32_32x32x32_bf16 v[112:127], v[52:55], v[152:159], v5
    ds_read_b64_tr_b16 v[48:49], v3 offset:7168
    v_exp_f32 v130, v130
    v_exp_f32 v131, v131
    v_exp_f32 v132, v132
    v_mfma_f32_32x32x16_bf16 v[144:159], v[16:19], v[12:15], 4.0
    ds_read_b64_tr_b16 v[50:51], v3 offset:7296
    v_exp_f32 v133, v133
    v_exp_f32 v134, v134
    v_exp_f32 v135, v135
    v_exp_f32 v136, v136
    v_exp_f32 v137, v137
    v_exp_f32 v138, v138
    v_smfmac_f32_32x32x32_bf16 v[96:111], v[40:43], v[128:135], v5
    v_exp_f32 v139, v139
    v_exp_f32 v140, v140
    v_exp_f32 v141, v141
    v_exp_f32 v142, v142
    v_exp_f32 v143, v143
    s_waitcnt lgkmcnt(0)
    v_exp_f32 v144, v144
    v_exp_f32 v145, v145
    v_smfmac_f32_32x32x32_bf16 v[96:111], v[44:47], v[136:143], v5
    ds_read_b64_tr_b16 v[52:53], v3 offset:7680
    v_exp_f32 v146, v146
    v_exp_f32 v147, v147
    v_exp_f32 v148, v148
    v_mfma_f32_32x32x16_bf16 v[128:143], v[20:23], v[8:11], 4.0
    ds_read_b64_tr_b16 v[54:55], v3 offset:7808
    v_exp_f32 v149, v149
    v_exp_f32 v150, v150
    v_exp_f32 v151, v151
    v_exp_f32 v152, v152
    v_exp_f32 v153, v153
    v_exp_f32 v154, v154
    v_smfmac_f32_32x32x32_bf16 v[112:127], v[40:43], v[144:151], v5
    ds_read_b128 v[16:19], v2 offset:57344
    v_exp_f32 v155, v155
    v_exp_f32 v156, v156
    v_exp_f32 v157, v157
    v_exp_f32 v158, v158
    v_exp_f32 v159, v159
    v_add_u32 v3, v4, v3
    v_exp_f32 v128, v128
    v_exp_f32 v129, v129
    v_smfmac_f32_32x32x32_bf16 v[112:127], v[44:47], v[152:159], v5
    ds_read_b64_tr_b16 v[40:41], v3 offset:0
    v_exp_f32 v130, v130
    v_exp_f32 v131, v131
    v_exp_f32 v132, v132
    v_mfma_f32_32x32x16_bf16 v[144:159], v[20:23], v[12:15], 4.0
    ds_read_b64_tr_b16 v[42:43], v3 offset:128
    v_exp_f32 v133, v133
    v_exp_f32 v134, v134
    v_exp_f32 v135, v135
    v_exp_f32 v136, v136
    v_exp_f32 v137, v137
    v_exp_f32 v138, v138
    v_smfmac_f32_32x32x32_bf16 v[96:111], v[48:51], v[128:135], v5
    v_exp_f32 v139, v139
    v_exp_f32 v140, v140
    v_exp_f32 v141, v141
    v_exp_f32 v142, v142
    v_exp_f32 v143, v143
    s_waitcnt lgkmcnt(0)
    v_exp_f32 v144, v144
    v_exp_f32 v145, v145
    v_smfmac_f32_32x32x32_bf16 v[96:111], v[52:55], v[136:143], v5
    ds_read_b64_tr_b16 v[44:45], v3 offset:512
    v_exp_f32 v146, v146
    v_exp_f32 v147, v147
    v_exp_f32 v148, v148
    v_mfma_f32_32x32x16_bf16 v[128:143], v[16:19], v[8:11], 4.0
    ds_read_b64_tr_b16 v[46:47], v3 offset:640
    v_exp_f32 v149, v149
    v_exp_f32 v150, v150
    v_exp_f32 v151, v151
    v_exp_f32 v152, v152
    v_exp_f32 v153, v153
    v_exp_f32 v154, v154
    v_smfmac_f32_32x32x32_bf16 v[112:127], v[48:51], v[144:151], v5
    ds_read_b128 v[20:23], v2 offset:58368
    v_exp_f32 v155, v155
    v_exp_f32 v156, v156
    v_exp_f32 v157, v157
    v_exp_f32 v158, v158
    v_exp_f32 v159, v159
    v_exp_f32 v128, v128
    v_exp_f32 v129, v129
    v_smfmac_f32_32x32x32_bf16 v[112:127], v[52:55], v[152:159], v5
    ds_read_b64_tr_b16 v[48:49], v3 offset:1024
    v_exp_f32 v130, v130
    v_exp_f32 v131, v131
    v_exp_f32 v132, v132
    v_mfma_f32_32x32x16_bf16 v[144:159], v[16:19], v[12:15], 4.0
    ds_read_b64_tr_b16 v[50:51], v3 offset:1152
    v_exp_f32 v133, v133
    v_exp_f32 v134, v134
    v_exp_f32 v135, v135
    v_exp_f32 v136, v136
    v_exp_f32 v137, v137
    v_exp_f32 v138, v138
    v_smfmac_f32_32x32x32_bf16 v[96:111], v[40:43], v[128:135], v5
    v_exp_f32 v139, v139
    v_exp_f32 v140, v140
    v_exp_f32 v141, v141
    v_exp_f32 v142, v142
    v_exp_f32 v143, v143
    s_waitcnt lgkmcnt(0)
    v_exp_f32 v144, v144
    v_exp_f32 v145, v145
    v_smfmac_f32_32x32x32_bf16 v[96:111], v[44:47], v[136:143], v5
    ds_read_b64_tr_b16 v[52:53], v3 offset:1536
    v_exp_f32 v146, v146
    v_exp_f32 v147, v147
    v_exp_f32 v148, v148
    v_mfma_f32_32x32x16_bf16 v[128:143], v[20:23], v[8:11], 4.0
    ds_read_b64_tr_b16 v[54:55], v3 offset:1664
    v_exp_f32 v149, v149
    v_exp_f32 v150, v150
    v_exp_f32 v151, v151
    v_exp_f32 v152, v152
    v_exp_f32 v153, v153
    v_exp_f32 v154, v154
    v_smfmac_f32_32x32x32_bf16 v[112:127], v[40:43], v[144:151], v5
    ds_read_b128 v[16:19], v2 offset:59392
    v_exp_f32 v155, v155
    v_exp_f32 v156, v156
    v_exp_f32 v157, v157
    v_exp_f32 v158, v158
    v_exp_f32 v159, v159
    v_exp_f32 v128, v128
    v_exp_f32 v129, v129
    v_smfmac_f32_32x32x32_bf16 v[112:127], v[44:47], v[152:159], v5
    ds_read_b64_tr_b16 v[40:41], v3 offset:2048
    v_exp_f32 v130, v130
    v_exp_f32 v131, v131
    v_exp_f32 v132, v132
    v_mfma_f32_32x32x16_bf16 v[144:159], v[20:23], v[12:15], 4.0
    ds_read_b64_tr_b16 v[42:43], v3 offset:2176
    v_exp_f32 v133, v133
    v_exp_f32 v134, v134
    v_exp_f32 v135, v135
    v_exp_f32 v136, v136
    v_exp_f32 v137, v137
    v_exp_f32 v138, v138
    v_smfmac_f32_32x32x32_bf16 v[96:111], v[48:51], v[128:135], v5
    v_exp_f32 v139, v139
    v_exp_f32 v140, v140
    v_exp_f32 v141, v141
    v_exp_f32 v142, v142
    v_exp_f32 v143, v143
    s_waitcnt lgkmcnt(0)
    v_exp_f32 v144, v144
    v_exp_f32 v145, v145
    v_smfmac_f32_32x32x32_bf16 v[96:111], v[52:55], v[136:143], v5
    ds_read_b64_tr_b16 v[44:45], v3 offset:2560
    v_exp_f32 v146, v146
    v_exp_f32 v147, v147
    v_exp_f32 v148, v148
    v_mfma_f32_32x32x16_bf16 v[128:143], v[16:19], v[8:11], 4.0
    ds_read_b64_tr_b16 v[46:47], v3 offset:2688
    v_exp_f32 v149, v149
    v_exp_f32 v150, v150
    v_exp_f32 v151, v151
    v_exp_f32 v152, v152
    v_exp_f32 v153, v153
    v_exp_f32 v154, v154
    v_smfmac_f32_32x32x32_bf16 v[112:127], v[48:51], v[144:151], v5
    ds_read_b128 v[20:23], v2 offset:60416
    v_exp_f32 v155, v155
    v_exp_f32 v156, v156
    v_exp_f32 v157, v157
    v_exp_f32 v158, v158
    v_exp_f32 v159, v159
    s_waitcnt lgkmcnt(0)
    v_exp_f32 v128, v128
    v_exp_f32 v129, v129
    v_smfmac_f32_32x32x32_bf16 v[112:127], v[52:55], v[152:159], v5
    ds_read_b128 v[24:27], v2 offset:61440
    ds_read_b64_tr_b16 v[48:49], v3 offset:3072
    v_exp_f32 v130, v130
    v_exp_f32 v131, v131
    v_exp_f32 v132, v132
    v_mfma_f32_32x32x16_bf16 v[144:159], v[20:23], v[8:11], 4.0
    ds_read_b64_tr_b16 v[50:51], v3 offset:3200
    ds_read_b64_tr_b16 v[52:53], v3 offset:3584
    v_exp_f32 v133, v133
    v_exp_f32 v134, v134
    v_exp_f32 v135, v135
    v_exp_f32 v136, v136
    v_exp_f32 v137, v137
    v_exp_f32 v138, v138
    v_smfmac_f32_32x32x32_bf16 v[96:111], v[40:43], v[128:135], v5
    ds_read_b64_tr_b16 v[54:55], v3 offset:3712
    v_exp_f32 v139, v139
    v_exp_f32 v140, v140
    v_exp_f32 v141, v141
    v_exp_f32 v142, v142
    v_exp_f32 v143, v143
    s_waitcnt lgkmcnt(2)
    v_exp_f32 v144, v144
    v_exp_f32 v145, v145
    v_smfmac_f32_32x32x32_bf16 v[96:111], v[44:47], v[136:143], v5
    ds_read_b128 v[28:31], v2 offset:62464
    ds_read_b64_tr_b16 v[56:57], v3 offset:4096
    v_exp_f32 v146, v146
    v_exp_f32 v147, v147
    v_exp_f32 v148, v148
    v_mfma_f32_32x32x16_bf16 v[128:143], v[24:27], v[8:11], 4.0
    ds_read_b64_tr_b16 v[58:59], v3 offset:4224
    ds_read_b64_tr_b16 v[60:61], v3 offset:4608
    v_exp_f32 v149, v149
    v_exp_f32 v150, v150
    v_exp_f32 v151, v151
    v_exp_f32 v152, v152
    v_exp_f32 v153, v153
    v_exp_f32 v154, v154
    v_smfmac_f32_32x32x32_bf16 v[96:111], v[48:51], v[144:151], v5
    ds_read_b64_tr_b16 v[62:63], v3 offset:4736
    v_exp_f32 v155, v155
    v_exp_f32 v156, v156
    v_exp_f32 v157, v157
    v_exp_f32 v158, v158
    v_exp_f32 v159, v159
    s_waitcnt lgkmcnt(2)
    v_exp_f32 v128, v128
    v_exp_f32 v129, v129
    v_smfmac_f32_32x32x32_bf16 v[96:111], v[52:55], v[152:159], v5
    ds_read_b128 v[32:35], v2 offset:63488
    ds_read_b64_tr_b16 v[64:65], v3 offset:5120
    v_exp_f32 v130, v130
    v_exp_f32 v131, v131
    v_exp_f32 v132, v132
    v_mfma_f32_32x32x16_bf16 v[144:159], v[28:31], v[8:11], 4.0
    ds_read_b64_tr_b16 v[66:67], v3 offset:5248
    ds_read_b64_tr_b16 v[68:69], v3 offset:5632
    v_exp_f32 v133, v133
    v_exp_f32 v134, v134
    v_exp_f32 v135, v135
    v_exp_f32 v136, v136
    v_exp_f32 v137, v137
    v_exp_f32 v138, v138
    v_smfmac_f32_32x32x32_bf16 v[96:111], v[56:59], v[128:135], v5
    ds_read_b64_tr_b16 v[70:71], v3 offset:5760
    v_exp_f32 v139, v139
    v_exp_f32 v140, v140
    v_exp_f32 v141, v141
    v_exp_f32 v142, v142
    v_exp_f32 v143, v143
    s_waitcnt lgkmcnt(2)
    v_exp_f32 v144, v144
    v_exp_f32 v145, v145
    v_smfmac_f32_32x32x32_bf16 v[96:111], v[60:63], v[136:143], v5
    ds_read_b128 v[36:39], v2 offset:64512
    ds_read_b64_tr_b16 v[72:73], v3 offset:6144
    v_exp_f32 v146, v146
    v_exp_f32 v147, v147
    v_exp_f32 v148, v148
    v_mfma_f32_32x32x16_bf16 v[128:143], v[32:35], v[8:11], 4.0
    ds_read_b64_tr_b16 v[74:75], v3 offset:6272
    ds_read_b64_tr_b16 v[76:77], v3 offset:6656
    v_exp_f32 v149, v149
    v_exp_f32 v150, v150
    v_exp_f32 v151, v151
    v_exp_f32 v152, v152
    v_exp_f32 v153, v153
    v_exp_f32 v154, v154
    v_smfmac_f32_32x32x32_bf16 v[96:111], v[64:67], v[144:151], v5
    ds_read_b64_tr_b16 v[78:79], v3 offset:6784
    v_exp_f32 v155, v155
    v_exp_f32 v156, v156
    v_exp_f32 v157, v157
    v_exp_f32 v158, v158
    v_exp_f32 v159, v159
    s_waitcnt lgkmcnt(2)
    v_exp_f32 v128, v128
    v_exp_f32 v129, v129
    v_smfmac_f32_32x32x32_bf16 v[96:111], v[68:71], v[152:159], v5
    ds_read_b64_tr_b16 v[80:81], v3 offset:7168
    v_exp_f32 v130, v130
    v_exp_f32 v131, v131
    v_exp_f32 v132, v132
    v_mfma_f32_32x32x16_bf16 v[144:159], v[36:39], v[8:11], 4.0
    ds_read_b64_tr_b16 v[82:83], v3 offset:7296
    ds_read_b64_tr_b16 v[84:85], v3 offset:7680
    v_exp_f32 v133, v133
    v_exp_f32 v134, v134
    v_exp_f32 v135, v135
    v_exp_f32 v136, v136
    v_exp_f32 v137, v137
    v_exp_f32 v138, v138
    v_smfmac_f32_32x32x32_bf16 v[96:111], v[72:75], v[128:135], v5
    ds_read_b64_tr_b16 v[86:87], v3 offset:7808
    v_exp_f32 v139, v139
    v_exp_f32 v140, v140
    v_exp_f32 v141, v141
    v_exp_f32 v142, v142
    v_exp_f32 v143, v143
    s_waitcnt lgkmcnt(2)
    v_exp_f32 v144, v144
    v_exp_f32 v145, v145
    v_smfmac_f32_32x32x32_bf16 v[96:111], v[76:79], v[136:143], v5
    v_exp_f32 v146, v146
    v_exp_f32 v147, v147
    v_exp_f32 v148, v148
    v_mfma_f32_32x32x16_bf16 v[128:143], v[16:19], v[12:15], 4.0
    v_exp_f32 v149, v149
    v_exp_f32 v150, v150
    v_exp_f32 v151, v151
    v_exp_f32 v152, v152
    v_exp_f32 v153, v153
    v_exp_f32 v154, v154
    v_smfmac_f32_32x32x32_bf16 v[96:111], v[80:83], v[144:151], v5
    v_exp_f32 v155, v155
    v_exp_f32 v156, v156
    v_exp_f32 v157, v157
    v_exp_f32 v158, v158
    v_exp_f32 v159, v159
    s_waitcnt lgkmcnt(0)
    v_exp_f32 v128, v128
    v_exp_f32 v129, v129
    v_smfmac_f32_32x32x32_bf16 v[96:111], v[84:87], v[152:159], v5
    v_exp_f32 v130, v130
    v_exp_f32 v131, v131
    v_exp_f32 v132, v132
    v_mfma_f32_32x32x16_bf16 v[144:159], v[20:23], v[12:15], 4.0
    v_exp_f32 v133, v133
    v_exp_f32 v134, v134
    v_exp_f32 v135, v135
    v_exp_f32 v136, v136
    v_exp_f32 v137, v137
    v_exp_f32 v138, v138
    v_smfmac_f32_32x32x32_bf16 v[112:127], v[40:43], v[128:135], v5
    v_exp_f32 v139, v139
    v_exp_f32 v140, v140
    v_exp_f32 v141, v141
    v_exp_f32 v142, v142
    v_exp_f32 v143, v143
    v_exp_f32 v144, v144
    v_exp_f32 v145, v145
    v_smfmac_f32_32x32x32_bf16 v[112:127], v[44:47], v[136:143], v5
    v_exp_f32 v146, v146
    v_exp_f32 v147, v147
    v_pk_add_f32 v[106:107], v[96:97], v[98:99]
    v_pk_add_f32 v[108:109], v[100:101], v[102:103]
    v_rcp_f32 v110, v104
    v_pk_add_f32 v[106:107], v[106:107], v[108:109]
    v_add_f32 v106, v106, v107
    v_fma_f32 v106, v106, 0, v104
    v_exp_f32 v148, v148
    v_mfma_f32_32x32x16_bf16 v[128:143], v[24:27], v[12:15], 4.0
    v_exp_f32 v149, v149
    v_subrev_u32 v106, 0x37800000, v106
    v_cmp_gt_u32 vcc, 0x3a000000, v106
    v_pk_mul_f32 v[96:97], v[96:97], v[110:111] op_sel_hi:[1,0]
    v_pk_mul_f32 v[98:99], v[98:99], v[110:111] op_sel_hi:[1,0]
    v_pk_mul_f32 v[100:101], v[100:101], v[110:111] op_sel_hi:[1,0]
    v_pk_mul_f32 v[102:103], v[102:103], v[110:111] op_sel_hi:[1,0]
    v_exp_f32 v150, v150
    v_exp_f32 v151, v151
    s_mov_b64 s[36:37], vcc
    v_cvt_pk_bf16_f32 v104, v96, v97
    v_cvt_pk_bf16_f32 v105, v98, v99
    v_cvt_pk_bf16_f32 v106, v100, v101
    v_cvt_pk_bf16_f32 v107, v102, v103
    v_exp_f32 v152, v152
    v_exp_f32 v153, v153
    v_exp_f32 v154, v154
    v_permlane32_swap_b32 v104, v106
    v_permlane32_swap_b32 v105, v107
    v_smfmac_f32_32x32x32_bf16 v[112:127], v[48:51], v[144:151], v5
    v_exp_f32 v155, v155
    v_exp_f32 v156, v156
    v_exp_f32 v157, v157
    buffer_store_dwordx4 v[104:107], v6, s[20:23], 0 offen offset:0 sc0 sc1 nt
    v_exp_f32 v158, v158
    v_exp_f32 v159, v159
    s_setprio 1
    v_exp_f32 v128, v128
    v_exp_f32 v129, v129
    v_smfmac_f32_32x32x32_bf16 v[112:127], v[52:55], v[152:159], v5
    v_exp_f32 v130, v130
    v_exp_f32 v131, v131
    v_exp_f32 v132, v132
    v_mfma_f32_32x32x16_bf16 v[144:159], v[28:31], v[12:15], 4.0
    v_exp_f32 v133, v133
    v_exp_f32 v134, v134
    v_exp_f32 v135, v135
    v_exp_f32 v136, v136
    v_exp_f32 v137, v137
    v_exp_f32 v138, v138
    v_smfmac_f32_32x32x32_bf16 v[112:127], v[56:59], v[128:135], v5
    v_exp_f32 v139, v139
    v_exp_f32 v140, v140
    v_exp_f32 v141, v141
    v_exp_f32 v142, v142
    v_exp_f32 v143, v143
    v_exp_f32 v144, v144
    v_exp_f32 v145, v145
    v_smfmac_f32_32x32x32_bf16 v[112:127], v[60:63], v[136:143], v5
    v_exp_f32 v146, v146
    v_exp_f32 v147, v147
    v_exp_f32 v148, v148
    v_mfma_f32_32x32x16_bf16 v[128:143], v[32:35], v[12:15], 4.0
    v_exp_f32 v149, v149
    v_exp_f32 v150, v150
    v_exp_f32 v151, v151
    v_exp_f32 v152, v152
    v_exp_f32 v153, v153
    v_exp_f32 v154, v154
    v_smfmac_f32_32x32x32_bf16 v[112:127], v[64:67], v[144:151], v5
    v_exp_f32 v155, v155
    v_exp_f32 v156, v156
    v_exp_f32 v157, v157
    v_exp_f32 v158, v158
    v_exp_f32 v159, v159
    v_exp_f32 v128, v128
    v_exp_f32 v129, v129
    v_smfmac_f32_32x32x32_bf16 v[112:127], v[68:71], v[152:159], v5
    v_exp_f32 v130, v130
    v_exp_f32 v131, v131
    v_exp_f32 v132, v132
    v_mfma_f32_32x32x16_bf16 v[144:159], v[36:39], v[12:15], 4.0
    v_exp_f32 v133, v133
    v_exp_f32 v134, v134
    v_exp_f32 v135, v135
    v_exp_f32 v136, v136
    v_exp_f32 v137, v137
    v_exp_f32 v138, v138
    v_smfmac_f32_32x32x32_bf16 v[112:127], v[72:75], v[128:135], v5
    v_exp_f32 v139, v139
    v_exp_f32 v140, v140
    v_exp_f32 v141, v141
    v_exp_f32 v142, v142
    v_exp_f32 v143, v143
    s_setprio 0
    v_exp_f32 v144, v144
    v_exp_f32 v145, v145
    v_smfmac_f32_32x32x32_bf16 v[112:127], v[76:79], v[136:143], v5
    v_exp_f32 v146, v146
    v_exp_f32 v147, v147
    v_exp_f32 v148, v148
    v_exp_f32 v149, v149
    v_exp_f32 v150, v150
    v_exp_f32 v151, v151
    v_exp_f32 v152, v152
    v_exp_f32 v153, v153
    v_exp_f32 v154, v154
    v_smfmac_f32_32x32x32_bf16 v[112:127], v[80:83], v[144:151], v5
    v_exp_f32 v155, v155
    v_exp_f32 v156, v156
    v_exp_f32 v157, v157
    v_exp_f32 v158, v158
    v_exp_f32 v159, v159
    s_nop 1
    v_smfmac_f32_32x32x32_bf16 v[112:127], v[84:87], v[152:159], v5
    s_nop 11
    v_rcp_f32 v126, v120
    v_pk_add_f32 v[122:123], v[112:113], v[114:115]
    v_pk_mul_f32 v[160:161], v[112:113], v[126:127] op_sel_hi:[1,0]
    v_pk_mul_f32 v[162:163], v[114:115], v[126:127] op_sel_hi:[1,0]
    v_pk_mul_f32 v[164:165], v[116:117], v[126:127] op_sel_hi:[1,0]
    v_pk_mul_f32 v[166:167], v[118:119], v[126:127] op_sel_hi:[1,0]
    v_cvt_pk_bf16_f32 v88, v160, v161
    v_cvt_pk_bf16_f32 v89, v162, v163
    v_cvt_pk_bf16_f32 v90, v164, v165
    v_cvt_pk_bf16_f32 v91, v166, v167
    v_pk_add_f32 v[124:125], v[116:117], v[118:119]
    v_pk_add_f32 v[122:123], v[122:123], v[124:125]
    v_permlane32_swap_b32 v88, v90
    v_permlane32_swap_b32 v89, v91
    v_add_f32 v122, v122, v123
    v_fma_f32 v122, v122, 0, v120
    buffer_store_dwordx4 v[88:91], v6, s[20:23], 0 offen offset:1024 sc0 sc1 nt
    v_subrev_u32 v122, 0x37800000, v122
    v_cmp_gt_u32 vcc, 0x3a000000, v122
    s_mov_b64 s[38:39], vcc
    s_and_b64 vcc, s[36:37], s[38:39]
    s_cmp_eq_u64 vcc, -1
    s_cbranch_scc0 L_slow0
L_done:
L_end:
    s_endpgm
L_slow0:
    s_cmp_eq_u64 s[36:37], -1
    s_cbranch_scc1 L_slow1
    buffer_load_dwordx4 v[8:11], v6, s[8:11], 0 offen offset:0
    s_waitcnt vmcnt(0)
    v_mov_b32 v176, 0xff7fffff
    v_lshlrev_b32 v178, 4, v1
    v_and_b32 v94, 15, v1
    v_lshlrev_b32 v94, 3, v94
    v_lshrrev_b32 v0, 5, v1
    v_lshl_add_u32 v179, v0, 8, v94
    v_add_u32 v179, 65536, v179
    v_and_b32 v94, 2, v1
    v_lshlrev_b32 v94, 2, v94
    v_add_u32 v94, 131200, v94
    v_and_b32 v0, 16, v1
    v_cmp_eq_u32 vcc, 0, v0
    v_mov_b32 v180, 1024
    v_mov_b32 v5, 0xdddddddd
    v_cndmask_b32 v179, v94, v179, vcc
    v_cndmask_b32 v180, 0, v180, vcc
    v_mov_b32 v96, 0
    v_mov_b32 v97, 0
    v_mov_b32 v98, 0
    v_mov_b32 v99, 0
    v_mov_b32 v100, 0
    v_mov_b32 v101, 0
    v_mov_b32 v102, 0
    v_mov_b32 v103, 0
    v_mov_b32 v104, 0
    v_mov_b32 v105, 0
    v_mov_b32 v106, 0
    v_mov_b32 v107, 0
    v_mov_b32 v108, 0
    v_mov_b32 v109, 0
    v_mov_b32 v110, 0
    v_mov_b32 v111, 0
    s_mov_b32 s26, 0
L_fb0:
    ds_read_b128 v[16:19], v178 offset:0
    ds_read_b64_tr_b16 v[40:41], v179
    ds_read_b64_tr_b16 v[42:43], v179 offset:128
    ds_read_b64_tr_b16 v[44:45], v179 offset:512
    ds_read_b64_tr_b16 v[46:47], v179 offset:640
    s_waitcnt lgkmcnt(0)
    v_mfma_f32_32x32x16_bf16 v[128:143], v[16:19], v[8:11], 0
    s_nop 15
    s_nop 7
    v_max3_f32 v94, v128, v129, v130
    v_max3_f32 v94, v94, v131, v132
    v_max3_f32 v94, v94, v133, v134
    v_max3_f32 v94, v94, v135, v136
    v_max3_f32 v94, v94, v137, v138
    v_max3_f32 v94, v94, v139, v140
    v_max3_f32 v94, v94, v141, v142
    v_max_f32 v94, v94, v143
    v_mov_b32 v0, v94
    s_nop 1
    v_permlane32_swap_b32 v94, v0
    s_nop 1
    v_max_f32 v94, v94, v0
    v_max_f32 v94, v94, v176
    v_sub_f32 v177, v176, v94
    v_mul_f32 v177, s30, v177
    v_exp_f32 v177, v177
    v_mov_b32 v176, v94
    v_mul_f32 v96, v177, v96
    v_mul_f32 v97, v177, v97
    v_mul_f32 v98, v177, v98
    v_mul_f32 v99, v177, v99
    v_mul_f32 v100, v177, v100
    v_mul_f32 v101, v177, v101
    v_mul_f32 v102, v177, v102
    v_mul_f32 v103, v177, v103
    v_mul_f32 v104, v177, v104
    v_mul_f32 v105, v177, v105
    v_mul_f32 v106, v177, v106
    v_mul_f32 v107, v177, v107
    v_mul_f32 v108, v177, v108
    v_mul_f32 v109, v177, v109
    v_mul_f32 v110, v177, v110
    v_mul_f32 v111, v177, v111
    v_sub_f32 v128, v128, v176
    v_sub_f32 v129, v129, v176
    v_sub_f32 v130, v130, v176
    v_sub_f32 v131, v131, v176
    v_sub_f32 v132, v132, v176
    v_sub_f32 v133, v133, v176
    v_sub_f32 v134, v134, v176
    v_sub_f32 v135, v135, v176
    v_sub_f32 v136, v136, v176
    v_sub_f32 v137, v137, v176
    v_sub_f32 v138, v138, v176
    v_sub_f32 v139, v139, v176
    v_sub_f32 v140, v140, v176
    v_sub_f32 v141, v141, v176
    v_sub_f32 v142, v142, v176
    v_sub_f32 v143, v143, v176
    v_mul_f32 v128, s30, v128
    v_mul_f32 v129, s30, v129
    v_mul_f32 v130, s30, v130
    v_mul_f32 v131, s30, v131
    v_mul_f32 v132, s30, v132
    v_mul_f32 v133, s30, v133
    v_mul_f32 v134, s30, v134
    v_mul_f32 v135, s30, v135
    v_mul_f32 v136, s30, v136
    v_mul_f32 v137, s30, v137
    v_mul_f32 v138, s30, v138
    v_mul_f32 v139, s30, v139
    v_mul_f32 v140, s30, v140
    v_mul_f32 v141, s30, v141
    v_mul_f32 v142, s30, v142
    v_mul_f32 v143, s30, v143
    v_exp_f32 v128, v128
    v_exp_f32 v129, v129
    v_exp_f32 v130, v130
    v_exp_f32 v131, v131
    v_exp_f32 v132, v132
    v_exp_f32 v133, v133
    v_exp_f32 v134, v134
    v_exp_f32 v135, v135
    v_exp_f32 v136, v136
    v_exp_f32 v137, v137
    v_exp_f32 v138, v138
    v_exp_f32 v139, v139
    v_exp_f32 v140, v140
    v_exp_f32 v141, v141
    v_exp_f32 v142, v142
    v_exp_f32 v143, v143
    s_nop 3
    v_smfmac_f32_32x32x32_bf16 v[96:111], v[40:43], v[128:135], v5
    v_smfmac_f32_32x32x32_bf16 v[96:111], v[44:47], v[136:143], v5
    v_add_u32 v178, 1024, v178
    v_add_u32 v179, v180, v179
    s_nop 15
    s_nop 7
    s_add_u32 s26, s26, 1
    s_cmp_lt_u32 s26, 64
    s_cbranch_scc1 L_fb0
    v_rcp_f32 v94, v104
    s_nop 1
    v_mul_f32 v96, v94, v96
    v_mul_f32 v97, v94, v97
    v_mul_f32 v98, v94, v98
    v_mul_f32 v99, v94, v99
    v_mul_f32 v100, v94, v100
    v_mul_f32 v101, v94, v101
    v_mul_f32 v102, v94, v102
    v_mul_f32 v103, v94, v103
    v_cvt_pk_bf16_f32 v104, v96, v97
    v_cvt_pk_bf16_f32 v105, v98, v99
    v_cvt_pk_bf16_f32 v106, v100, v101
    v_cvt_pk_bf16_f32 v107, v102, v103
    s_nop 1
    v_permlane32_swap_b32 v104, v106
    v_permlane32_swap_b32 v105, v107
    s_nop 1
    buffer_store_dwordx4 v[104:107], v6, s[20:23], 0 offen offset:0 sc0 sc1
L_slow1:
    s_cmp_eq_u64 s[38:39], -1
    s_cbranch_scc1 L_done
    buffer_load_dwordx4 v[12:15], v6, s[8:11], 0 offen offset:1024
    s_waitcnt vmcnt(0)
    v_mov_b32 v176, 0xff7fffff
    v_lshlrev_b32 v178, 4, v1
    v_and_b32 v94, 15, v1
    v_lshlrev_b32 v94, 3, v94
    v_lshrrev_b32 v0, 5, v1
    v_lshl_add_u32 v179, v0, 8, v94
    v_add_u32 v179, 65536, v179
    v_and_b32 v94, 2, v1
    v_lshlrev_b32 v94, 2, v94
    v_add_u32 v94, 131200, v94
    v_and_b32 v0, 16, v1
    v_cmp_eq_u32 vcc, 0, v0
    v_mov_b32 v180, 1024
    v_mov_b32 v5, 0xdddddddd
    v_cndmask_b32 v179, v94, v179, vcc
    v_cndmask_b32 v180, 0, v180, vcc
    v_mov_b32 v112, 0
    v_mov_b32 v113, 0
    v_mov_b32 v114, 0
    v_mov_b32 v115, 0
    v_mov_b32 v116, 0
    v_mov_b32 v117, 0
    v_mov_b32 v118, 0
    v_mov_b32 v119, 0
    v_mov_b32 v120, 0
    v_mov_b32 v121, 0
    v_mov_b32 v122, 0
    v_mov_b32 v123, 0
    v_mov_b32 v124, 0
    v_mov_b32 v125, 0
    v_mov_b32 v126, 0
    v_mov_b32 v127, 0
    s_mov_b32 s26, 0
L_fb1:
    ds_read_b128 v[16:19], v178 offset:0
    ds_read_b64_tr_b16 v[40:41], v179
    ds_read_b64_tr_b16 v[42:43], v179 offset:128
    ds_read_b64_tr_b16 v[44:45], v179 offset:512
    ds_read_b64_tr_b16 v[46:47], v179 offset:640
    s_waitcnt lgkmcnt(0)
    v_mfma_f32_32x32x16_bf16 v[128:143], v[16:19], v[12:15], 0
    s_nop 15
    s_nop 7
    v_max3_f32 v94, v128, v129, v130
    v_max3_f32 v94, v94, v131, v132
    v_max3_f32 v94, v94, v133, v134
    v_max3_f32 v94, v94, v135, v136
    v_max3_f32 v94, v94, v137, v138
    v_max3_f32 v94, v94, v139, v140
    v_max3_f32 v94, v94, v141, v142
    v_max_f32 v94, v94, v143
    v_mov_b32 v0, v94
    s_nop 1
    v_permlane32_swap_b32 v94, v0
    s_nop 1
    v_max_f32 v94, v94, v0
    v_max_f32 v94, v94, v176
    v_sub_f32 v177, v176, v94
    v_mul_f32 v177, s30, v177
    v_exp_f32 v177, v177
    v_mov_b32 v176, v94
    v_mul_f32 v112, v177, v112
    v_mul_f32 v113, v177, v113
    v_mul_f32 v114, v177, v114
    v_mul_f32 v115, v177, v115
    v_mul_f32 v116, v177, v116
    v_mul_f32 v117, v177, v117
    v_mul_f32 v118, v177, v118
    v_mul_f32 v119, v177, v119
    v_mul_f32 v120, v177, v120
    v_mul_f32 v121, v177, v121
    v_mul_f32 v122, v177, v122
    v_mul_f32 v123, v177, v123
    v_mul_f32 v124, v177, v124
    v_mul_f32 v125, v177, v125
    v_mul_f32 v126, v177, v126
    v_mul_f32 v127, v177, v127
    v_sub_f32 v128, v128, v176
    v_sub_f32 v129, v129, v176
    v_sub_f32 v130, v130, v176
    v_sub_f32 v131, v131, v176
    v_sub_f32 v132, v132, v176
    v_sub_f32 v133, v133, v176
    v_sub_f32 v134, v134, v176
    v_sub_f32 v135, v135, v176
    v_sub_f32 v136, v136, v176
    v_sub_f32 v137, v137, v176
    v_sub_f32 v138, v138, v176
    v_sub_f32 v139, v139, v176
    v_sub_f32 v140, v140, v176
    v_sub_f32 v141, v141, v176
    v_sub_f32 v142, v142, v176
    v_sub_f32 v143, v143, v176
    v_mul_f32 v128, s30, v128
    v_mul_f32 v129, s30, v129
    v_mul_f32 v130, s30, v130
    v_mul_f32 v131, s30, v131
    v_mul_f32 v132, s30, v132
    v_mul_f32 v133, s30, v133
    v_mul_f32 v134, s30, v134
    v_mul_f32 v135, s30, v135
    v_mul_f32 v136, s30, v136
    v_mul_f32 v137, s30, v137
    v_mul_f32 v138, s30, v138
    v_mul_f32 v139, s30, v139
    v_mul_f32 v140, s30, v140
    v_mul_f32 v141, s30, v141
    v_mul_f32 v142, s30, v142
    v_mul_f32 v143, s30, v143
    v_exp_f32 v128, v128
    v_exp_f32 v129, v129
    v_exp_f32 v130, v130
    v_exp_f32 v131, v131
    v_exp_f32 v132, v132
    v_exp_f32 v133, v133
    v_exp_f32 v134, v134
    v_exp_f32 v135, v135
    v_exp_f32 v136, v136
    v_exp_f32 v137, v137
    v_exp_f32 v138, v138
    v_exp_f32 v139, v139
    v_exp_f32 v140, v140
    v_exp_f32 v141, v141
    v_exp_f32 v142, v142
    v_exp_f32 v143, v143
    s_nop 3
    v_smfmac_f32_32x32x32_bf16 v[112:127], v[40:43], v[128:135], v5
    v_smfmac_f32_32x32x32_bf16 v[112:127], v[44:47], v[136:143], v5
    v_add_u32 v178, 1024, v178
    v_add_u32 v179, v180, v179
    s_nop 15
    s_nop 7
    s_add_u32 s26, s26, 1
    s_cmp_lt_u32 s26, 64
    s_cbranch_scc1 L_fb1
    v_rcp_f32 v94, v120
    s_nop 1
    v_mul_f32 v112, v94, v112
    v_mul_f32 v113, v94, v113
    v_mul_f32 v114, v94, v114
    v_mul_f32 v115, v94, v115
    v_mul_f32 v116, v94, v116
    v_mul_f32 v117, v94, v117
    v_mul_f32 v118, v94, v118
    v_mul_f32 v119, v94, v119
    v_cvt_pk_bf16_f32 v120, v112, v113
    v_cvt_pk_bf16_f32 v121, v114, v115
    v_cvt_pk_bf16_f32 v122, v116, v117
    v_cvt_pk_bf16_f32 v123, v118, v119
    s_nop 1
    v_permlane32_swap_b32 v120, v122
    v_permlane32_swap_b32 v121, v123
    s_nop 1
    buffer_store_dwordx4 v[120:123], v6, s[20:23], 0 offen offset:1024 sc0 sc1
    s_branch L_done
.section .rodata,"a"
.p2align 6
.amdhsa_kernel standalone__fused_io_aware_attn__prompt_kernel
  .amdhsa_next_free_vgpr 224
  .amdhsa_next_free_sgpr 56
  .amdhsa_accum_offset 224
  .amdhsa_group_segment_fixed_size 0
  .amdhsa_kernarg_size 48
  .amdhsa_user_sgpr_count 2
  .amdhsa_user_sgpr_kernarg_segment_ptr 1
  .amdhsa_system_sgpr_workgroup_id_x 1
.end_amdhsa_kernel
```
